```python
import torch

def _softmax(x, axis=-1):
    return torch.softmax(x, dim=axis)
def _gelu(x):
    return torch.nn.functional.gelu(x, approximate="tanh")
def _silu(x):
    return torch.nn.functional.silu(x)
def _sigmoid(x):
    return torch.sigmoid(x)
def _layernorm(x, axis=-1, eps=1e-5):
    m = x.mean(dim=axis, keepdim=True)
    v = x.var(dim=axis, keepdim=True, unbiased=False)
    return (x - m) / torch.sqrt(v + eps)
def _scatter_add(tgt, idx, src, axis=0):
    return tgt.clone().index_add_(axis, idx, src)
def _segment_sum(src, seg, n):
    out = torch.zeros((n,) + src.shape[1:], dtype=src.dtype)
    return out.index_add_(0, seg, src)
def _pad(x, pw):
    flat = tuple(v for pair in reversed(pw) for v in pair)
    return torch.nn.functional.pad(x, flat)

kernel_name = 'gated_mix__sliding_block_cached__swiglu_ffn__decode'

def setup_inputs():

    _w = (lambda a: (lambda t: t.to(torch.bfloat16) if t.is_floating_point() else t)(torch.as_tensor(a)))
    def _A_setup():
        B, Sq, D = 1, 1, 576
        Hq, Hkv, Sk, Dh = 32, 16, 65536, 128
        assert Hq % Hkv == 0, (Hq, Hkv)
        return {
            "x": _w((lambda *s: torch.randn(*s, dtype=torch.bfloat16) * 0.05)(B, Sq, D)),
            "k_cache": _w((lambda *s: torch.randn(*s, dtype=torch.bfloat16) * 6.4)(B, Hkv, Sk, Dh)),
            "v_cache": _w((lambda *s: torch.randn(*s, dtype=torch.bfloat16) * 0.2)(B, Hkv, Sk, Dh)),
            "wq": _w((lambda *s: torch.randn(*s, dtype=torch.bfloat16) * 6.4)(D, Hq * Dh) * (D ** -0.5)),
            "wo": _w((lambda *s: torch.randn(*s, dtype=torch.bfloat16) * 0.2)(Hq * Dh, D) * ((Hq * Dh) ** -0.5)),
        }
    _A_in = _A_setup()

    def _B_setup():
        B, S, D, F = 1, 1, 576, 4608
        return {
            "x": _w((lambda *s: torch.randn(*s, dtype=torch.bfloat16) * 0.05)(B, S, D)),
            "w_gate": _w((lambda *s: torch.randn(*s, dtype=torch.bfloat16) * 0.05)(D, F)),
            "w_up": _w((lambda *s: torch.randn(*s, dtype=torch.bfloat16) * 0.05)(D, F)),
            "w_down": _w((lambda *s: torch.randn(*s, dtype=torch.bfloat16) * 0.05)(F, D)),
        }
    _B_in = _B_setup()

    return {
        "A_x": _A_in["x"],
        "A_k_cache": _A_in["k_cache"],
        "A_v_cache": _A_in["v_cache"],
        "A_wq": _A_in["wq"],
        "A_wo": _A_in["wo"],
        "B_x": _B_in["x"],
        "B_w_gate": _B_in["w_gate"],
        "B_w_up": _B_in["w_up"],
        "B_w_down": _B_in["w_down"],
        "gate_w": _w((lambda *s: torch.randn(*s, dtype=torch.bfloat16) * 0.1)(576) * 16.0),
    }

def reference(A_x, A_k_cache, A_v_cache, A_wq, A_wo, B_x, B_w_gate, B_w_up, B_w_down, gate_w):
    def _A_ref(x, k_cache, v_cache, wq, wo):
        B, Sq, D = x.shape
        Hq, Dh = 32, 128
        Hkv, Sk = k_cache.shape[1], k_cache.shape[2]
        W = min(4096, max(256, Sk // 4))
        rep = Hq // Hkv
        q = (lambda x, *d: x.permute(*d))((x @ wq).reshape(B, Sq, Hq, Dh), 0, 2, 1, 3)
        k = (lambda x, n, axis: torch.repeat_interleave(x, n, dim=axis))(k_cache[:, :, Sk - W:, :], rep, axis=1)
        v = (lambda x, n, axis: torch.repeat_interleave(x, n, dim=axis))(v_cache[:, :, Sk - W:, :], rep, axis=1)
        scores = torch.einsum("bhqd,bhkd->bhqk", q, k) * (Dh ** -0.5)
        p = _softmax(scores, axis=-1)
        o = torch.einsum("bhqk,bhkd->bhqd", p, v)
        return (lambda x, *d: x.permute(*d))(o, 0, 2, 1, 3).reshape(B, Sq, Hq * Dh) @ wo

    def _B_ref(x, w_gate, w_up, w_down):
        g = _silu(x @ w_gate)
        u = x @ w_up
        return (g * u) @ w_down

    x = A_x
    g = _sigmoid((x * gate_w).sum(-1, keepdims=True))
    a = _A_ref(x, A_k_cache, A_v_cache, A_wq, A_wo)
    b = _B_ref(x, B_w_gate, B_w_up, B_w_down)
    return g * a + (1 - g) * b
```

```asm
; @launch grid=(256,1,1) block=(704,1,1) lds=163840
.amdgcn_target "amdgcn-amd-amdhsa--gfx950"
.text
.globl gated_mix__sliding_block_cached__swiglu_ffn__decode_kernel
.p2align 8
.type gated_mix__sliding_block_cached__swiglu_ffn__decode_kernel,@function
gated_mix__sliding_block_cached__swiglu_ffn__decode_kernel:
    s_load_dwordx2 s[36:37], s[0:1], 8
    s_load_dwordx16 s[4:19], s[0:1], 0
    s_cmpk_ge_u32 s2, 0x100
    s_cbranch_scc1 L_end
    v_cmp_gt_u32 vcc, 64, v0
    s_cbranch_vccz L_other
    s_lshr_b32 s31, s2, 4
    s_lshl_b32 s61, s2, 28
    s_lshr_b32 s61, s61, 4
    s_add_u32 s67, s31, 240
    s_lshl_b32 s67, s67, 16
    s_or_b32 s61, s61, s67
    s_add_u32 s67, s2, s31
    s_and_b32 s67, s67, 15
    s_lshl_b32 s67, s67, 12
    s_or_b32 s69, s61, s67
    v_lshlrev_b32 v12, 4, v0
    v_and_b32 v2, 48, v0
    v_xor_b32 v8, v12, v2
    v_xor_b32 v9, 64, v8
    v_xor_b32 v10, 128, v8
    v_xor_b32 v11, 64, v10
    s_lshl_b32 s38, 1, 28
    s_mov_b32 s39, 0x20000
    s_mov_b32 m0, 0
    s_waitcnt lgkmcnt(0)
    buffer_load_dwordx4 v8, s[36:39], s69 offen nt lds
    buffer_load_dwordx4 v9, s[36:39], s69 offen offset:1024 nt lds
    buffer_load_dwordx4 v10, s[36:39], s69 offen offset:2048 nt lds
    buffer_load_dwordx4 v11, s[36:39], s69 offen offset:3072 nt lds
    s_setprio 3
    s_load_dwordx8 s[20:27], s[0:1], 64
    s_load_dwordx2 s[28:29], s[0:1], 96
    s_add_u32 m0, m0, 4096
    s_add_u32 s67, s67, 4096
    s_and_b32 s67, s67, 0xffff
    s_or_b32 s69, s61, s67
    buffer_load_dwordx4 v8, s[36:39], s69 offen nt lds
    buffer_load_dwordx4 v9, s[36:39], s69 offen offset:1024 nt lds
    buffer_load_dwordx4 v10, s[36:39], s69 offen offset:2048 nt lds
    buffer_load_dwordx4 v11, s[36:39], s69 offen offset:3072 nt lds
    s_add_u32 m0, m0, 4096
    s_add_u32 s67, s67, 4096
    s_and_b32 s67, s67, 0xffff
    s_or_b32 s69, s61, s67
    buffer_load_dwordx4 v8, s[36:39], s69 offen nt lds
    buffer_load_dwordx4 v9, s[36:39], s69 offen offset:1024 nt lds
    buffer_load_dwordx4 v10, s[36:39], s69 offen offset:2048 nt lds
    buffer_load_dwordx4 v11, s[36:39], s69 offen offset:3072 nt lds
    s_add_u32 m0, m0, 4096
    s_add_u32 s67, s67, 4096
    s_and_b32 s67, s67, 0xffff
    s_or_b32 s69, s61, s67
    buffer_load_dwordx4 v8, s[36:39], s69 offen nt lds
    buffer_load_dwordx4 v9, s[36:39], s69 offen offset:1024 nt lds
    buffer_load_dwordx4 v10, s[36:39], s69 offen offset:2048 nt lds
    buffer_load_dwordx4 v11, s[36:39], s69 offen offset:3072 nt lds
    s_add_u32 m0, m0, 4096
    s_add_u32 s67, s67, 4096
    s_and_b32 s67, s67, 0xffff
    s_or_b32 s69, s61, s67
    v_mov_b32 v1, 162368
    s_and_b32 s62, s2, 7
    s_bfe_u32 s65, s2, 0x10003
    s_and_b32 s30, s2, 15
    s_lshr_b32 s31, s2, 4
    s_mov_b32 s34, 0x2000000
    v_lshrrev_b32 v6, 3, v0
    v_and_b32 v7, 7, v0
    v_lshlrev_b32 v7, 4, v7
    s_lshr_b32 s35, s2, 3
    s_mul_i32 s64, s35, 22
    s_sub_u32 s64, s64, 378
    s_cmp_eq_u32 s35, 31
    s_subb_u32 s64, s64, 0
    s_cmp_ge_u32 s35, 30
    s_cselect_b32 s63, 21, 22
    s_lshr_b32 s35, s31, 1
    s_cmp_eq_u32 s31, 8
    s_cselect_b32 s35, s65, s35
    s_mul_i32 s35, s35, 9
    s_cmp_lt_u32 s31, 9
    s_cselect_b32 s64, s35, s64
    s_cselect_b32 s63, 9, s63
    s_mul_i32 s66, s64, 1821
    s_lshr_b32 s66, s66, 16
    s_cmp_lt_u32 s31, 8
    s_mov_b32 s57, 9216
    s_cselect_b32 s57, 8192, s57
    s_cselect_b32 s48, s10, s16
    s_cselect_b32 s49, s11, s17
    s_cselect_b32 s40, s10, s18
    s_cselect_b32 s41, s11, s19
    s_lshl_b32 s58, s57, 1
    v_mul_u32_u24 v16, s58, v6
    v_add_u32 v16, v16, v7
    s_sub_u32 s58, s57, 1024
    v_add_u32 v17, s58, v16
    s_lshl_b32 s58, s57, 4
    s_mul_i32 s50, s57, 575
    s_add_u32 s50, s50, 128
    s_mov_b32 s51, 0x20000
    s_add_u32 s42, s50, 2048
    s_mov_b32 s43, 0x20000
    s_mul_i32 s35, s66, 36
    s_sub_u32 s59, s64, s35
    s_mul_i32 s69, s59, s58
    s_and_b32 s44, s31, 1
    s_lshl_b32 s44, s44, 8
    s_lshl_b32 s45, s30, 9
    s_add_u32 s44, s44, s45
    s_mul_i32 s33, s62, 1152
    s_lshl_b32 s45, s66, 7
    s_add_u32 s45, s45, s33
    s_add_u32 s52, s66, 4
    s_sub_u32 s53, s52, 9
    s_cselect_b32 s52, s52, s53
    s_lshl_b32 s53, s52, 7
    s_add_u32 s53, s53, s33
    s_add_u32 s54, s44, 128
    s_cmp_lt_u32 s31, 8
    s_cselect_b32 s56, s44, s45
    s_cselect_b32 s53, s54, s53
    s_add_u32 s48, s48, s56
    s_addc_u32 s49, s49, 0
    s_add_u32 s40, s40, s53
    s_addc_u32 s41, s41, 0
    s_sub_u32 s40, s40, 2048
    s_subb_u32 s41, s41, 0
    s_mov_b32 m0, 57344
    s_mov_b32 s68, 16
    s_lshl_b32 s63, s63, 2
    s_add_u32 s63, s63, s68
    v_mov_b32 v13, 41
L_P:
    s_waitcnt vmcnt(23)
    buffer_load_dwordx4 v16, s[48:51], s69 offen nt lds
    v_add_u32 v2, s68, v13
    ds_write_b32 v1, v2 offset:0
    s_waitcnt vmcnt(23)
    buffer_load_dwordx4 v16, s[40:43], s69 offen offset:2048 nt lds
    s_waitcnt vmcnt(23)
    buffer_load_dwordx4 v17, s[48:51], s69 offen offset:1024 nt lds
    s_waitcnt vmcnt(23)
    buffer_load_dwordx4 v17, s[40:43], s69 offen offset:3072 nt lds
    s_add_u32 s68, s68, 4
    s_add_u32 m0, m0, 4096
    s_cmp_lg_u32 s68, 32
    s_cbranch_scc1 L_P1
    s_barrier
L_P1:
    s_add_u32 s69, s69, s58
    s_add_u32 s59, s59, 1
    s_cmp_lg_u32 s59, 36
    s_cbranch_scc1 L_Pn
    s_mov_b32 s59, 0
    s_mov_b32 s69, 0
    s_add_u32 s48, s48, 128
    s_addc_u32 s49, s49, 0
    s_add_u32 s40, s40, 128
    s_addc_u32 s41, s41, 0
    s_cmp_lg_u32 s52, 8
    s_cbranch_scc1 L_Pn
    s_sub_u32 s40, s40, 1152
    s_subb_u32 s41, s41, 0
L_Pn:
    s_cmp_lt_u32 s68, s63
    s_cbranch_scc1 L_P
    s_or_b32 s69, s61, s67
    s_mov_b32 s40, s8
    s_mov_b32 s41, s9
    s_mov_b32 s42, s38
    s_cmp_ge_u32 s31, 9
    s_cbranch_scc1 L_ldya
    v_mov_b32 v13, 41
    s_mov_b32 m0, 16384
    s_add_u32 s63, s68, 40
S4_1:
    s_waitcnt vmcnt(23)
    buffer_load_dwordx4 v8, s[36:39], s69 offen nt lds
    v_add_u32 v2, s68, v13
    ds_write_b32 v1, v2 offset:0
    s_waitcnt vmcnt(23)
    buffer_load_dwordx4 v9, s[36:39], s69 offen offset:1024 nt lds
    s_waitcnt vmcnt(23)
    buffer_load_dwordx4 v10, s[36:39], s69 offen offset:2048 nt lds
    s_waitcnt vmcnt(23)
    buffer_load_dwordx4 v11, s[36:39], s69 offen offset:3072 nt lds
    s_add_u32 s68, s68, 4
    s_add_u32 m0, m0, 4096
    s_add_u32 s67, s67, 4096
    s_and_b32 s67, s67, 0xffff
    s_or_b32 s69, s61, s67
    s_cmp_lt_u32 s68, s63
    s_cbranch_scc1 S4_1
    s_branch SD_3
SP_2:
    s_sleep 1
SD_3:
    ds_read_b32 v2, v1 offset:28
    s_sub_u32 s34, s34, 1
    s_cbranch_scc1 L_end
    s_waitcnt lgkmcnt(0)
    v_readfirstlane_b32 s35, v2
    s_cmp_lt_u32 s35, 2
    s_cbranch_scc1 SP_2
    s_add_u32 s63, s68, 8
S4_4:
    s_waitcnt vmcnt(23)
    buffer_load_dwordx4 v8, s[36:39], s69 offen nt lds
    v_add_u32 v2, s68, v13
    ds_write_b32 v1, v2 offset:0
    s_waitcnt vmcnt(23)
    buffer_load_dwordx4 v9, s[36:39], s69 offen offset:1024 nt lds
    s_waitcnt vmcnt(23)
    buffer_load_dwordx4 v10, s[36:39], s69 offen offset:2048 nt lds
    s_waitcnt vmcnt(23)
    buffer_load_dwordx4 v11, s[36:39], s69 offen offset:3072 nt lds
    s_add_u32 s68, s68, 4
    s_add_u32 m0, m0, 4096
    s_add_u32 s67, s67, 4096
    s_and_b32 s67, s67, 0xffff
    s_or_b32 s69, s61, s67
    s_cmp_lt_u32 s68, s63
    s_cbranch_scc1 S4_4
    s_add_u32 s63, s68, 64
S4_5:
    s_waitcnt vmcnt(23)
    buffer_load_dwordx4 v12, s[40:43], s69 offen nt lds
    v_add_u32 v2, s68, v13
    ds_write_b32 v1, v2 offset:0
    s_waitcnt vmcnt(23)
    buffer_load_dwordx4 v12, s[40:43], s69 offen offset:1024 nt lds
    s_waitcnt vmcnt(23)
    buffer_load_dwordx4 v12, s[40:43], s69 offen offset:2048 nt lds
    s_waitcnt vmcnt(23)
    buffer_load_dwordx4 v12, s[40:43], s69 offen offset:3072 nt lds
    s_add_u32 s68, s68, 4
    s_add_u32 m0, m0, 4096
    s_add_u32 s67, s67, 4096
    s_and_b32 s67, s67, 0xffff
    s_or_b32 s69, s61, s67
    s_cmp_lt_u32 s68, s63
    s_cbranch_scc1 S4_5
    v_mul_u32_u24 v16, 1152, v6
    v_add_u32 v16, v16, v7
    v_add_u32 v17, 8192, v16
    v_add_u32 v18, 16384, v16
    v_add_u32 v19, 24576, v16
    s_lshl_b32 s35, s31, 7
    s_lshl_b32 s44, s62, 1
    s_or_b32 s44, s44, s65
    s_mul_i32 s44, s44, 288*1152
    s_add_u32 s44, s44, s35
    s_mul_i32 s45, s30, 256*1152
    s_add_u32 s45, s45, s35
    s_add_u32 s48, s20, s44
    s_addc_u32 s49, s21, 0
    s_mov_b32 s50, 330752
    s_mov_b32 s51, 0x20000
    s_add_u32 s52, s12, s45
    s_addc_u32 s53, s13, 0
    s_mov_b32 s54, 293888
    s_mov_b32 s55, 0x20000
    v_mov_b32 v13, 51
    s_branch SD_7
SP_6:
    s_sleep 1
SD_7:
    ds_read_b32 v2, v1 offset:16
    s_sub_u32 s34, s34, 1
    s_cbranch_scc1 L_end
    s_waitcnt lgkmcnt(0)
    v_readfirstlane_b32 s35, v2
    s_cmp_lt_u32 s35, 4
    s_cbranch_scc1 SP_6
    s_mov_b32 m0, 0
    s_mov_b32 s69, 0
    s_add_u32 s63, s68, 28
S4_8:
    s_waitcnt vmcnt(13)
    buffer_load_dwordx4 v16, s[48:51], s69 offen nt lds
    v_add_u32 v2, s68, v13
    ds_write_b32 v1, v2 offset:0
    s_waitcnt vmcnt(13)
    buffer_load_dwordx4 v17, s[48:51], s69 offen offset:1024 nt lds
    s_waitcnt vmcnt(13)
    buffer_load_dwordx4 v18, s[48:51], s69 offen offset:2048 nt lds
    s_waitcnt vmcnt(13)
    buffer_load_dwordx4 v19, s[48:51], s69 offen offset:3072 nt lds
    s_add_u32 s68, s68, 4
    s_add_u32 m0, m0, 4096
    s_add_u32 s69, s69, 36864
    s_cmp_lt_u32 s68, s63
    s_cbranch_scc1 S4_8
    v_mov_b32 v13, 31
    s_add_u32 s63, s68, 8
S4_9:
    s_waitcnt vmcnt(33)
    buffer_load_dwordx4 v16, s[48:51], s69 offen nt lds
    v_add_u32 v2, s68, v13
    ds_write_b32 v1, v2 offset:0
    s_waitcnt vmcnt(33)
    buffer_load_dwordx4 v17, s[48:51], s69 offen offset:1024 nt lds
    s_waitcnt vmcnt(33)
    buffer_load_dwordx4 v18, s[48:51], s69 offen offset:2048 nt lds
    s_waitcnt vmcnt(33)
    buffer_load_dwordx4 v19, s[48:51], s69 offen offset:3072 nt lds
    s_add_u32 s68, s68, 4
    s_add_u32 m0, m0, 4096
    s_add_u32 s69, s69, 36864
    s_cmp_lt_u32 s68, s63
    s_cbranch_scc1 S4_9
    s_mov_b32 s69, 0
    s_add_u32 s63, s68, 28
S4_10:
    s_waitcnt vmcnt(33)
    buffer_load_dwordx4 v16, s[52:55], s69 offen nt lds
    v_add_u32 v2, s68, v13
    ds_write_b32 v1, v2 offset:0
    s_waitcnt vmcnt(33)
    buffer_load_dwordx4 v17, s[52:55], s69 offen offset:1024 nt lds
    s_waitcnt vmcnt(33)
    buffer_load_dwordx4 v18, s[52:55], s69 offen offset:2048 nt lds
    s_waitcnt vmcnt(33)
    buffer_load_dwordx4 v19, s[52:55], s69 offen offset:3072 nt lds
    s_add_u32 s68, s68, 4
    s_add_u32 m0, m0, 4096
    s_add_u32 s69, s69, 36864
    s_cmp_lt_u32 s68, s63
    s_cbranch_scc1 S4_10
    s_mov_b32 m0, 131072
    s_waitcnt vmcnt(33)
    buffer_load_dwordx4 v16, s[52:55], s69 offen nt lds
    v_add_u32 v2, s68, v13
    ds_write_b32 v1, v2 offset:0
    s_waitcnt vmcnt(33)
    buffer_load_dwordx4 v17, s[52:55], s69 offen offset:1024 nt lds
    s_waitcnt vmcnt(33)
    buffer_load_dwordx4 v18, s[52:55], s69 offen offset:2048 nt lds
    s_waitcnt vmcnt(33)
    buffer_load_dwordx4 v19, s[52:55], s69 offen offset:3072 nt lds
    s_add_u32 s68, s68, 4
    s_add_u32 m0, m0, 4096
    s_add_u32 s35, s68, 31
    v_mov_b32 v2, s35
    s_waitcnt vmcnt(33)
    ds_write_b32 v1, v2 offset:0
    s_add_u32 s35, s68, 32
    v_mov_b32 v2, s35
    s_waitcnt vmcnt(32)
    ds_write_b32 v1, v2 offset:0
    s_add_u32 s35, s68, 34
    v_mov_b32 v2, s35
    s_waitcnt vmcnt(30)
    ds_write_b32 v1, v2 offset:0
    s_add_u32 s35, s68, 36
    v_mov_b32 v2, s35
    s_waitcnt vmcnt(28)
    ds_write_b32 v1, v2 offset:0
    s_add_u32 s35, s68, 38
    v_mov_b32 v2, s35
    s_waitcnt vmcnt(26)
    ds_write_b32 v1, v2 offset:0
    s_add_u32 s35, s68, 40
    v_mov_b32 v2, s35
    s_waitcnt vmcnt(24)
    ds_write_b32 v1, v2 offset:0
    s_add_u32 s35, s68, 42
    v_mov_b32 v2, s35
    s_waitcnt vmcnt(22)
    ds_write_b32 v1, v2 offset:0
    s_add_u32 s35, s68, 44
    v_mov_b32 v2, s35
    s_waitcnt vmcnt(20)
    ds_write_b32 v1, v2 offset:0
    s_add_u32 s35, s68, 46
    v_mov_b32 v2, s35
    s_waitcnt vmcnt(18)
    ds_write_b32 v1, v2 offset:0
    s_add_u32 s35, s68, 48
    v_mov_b32 v2, s35
    s_waitcnt vmcnt(16)
    ds_write_b32 v1, v2 offset:0
    s_add_u32 s35, s68, 50
    v_mov_b32 v2, s35
    s_waitcnt vmcnt(14)
    ds_write_b32 v1, v2 offset:0
    s_add_u32 s35, s68, 52
    v_mov_b32 v2, s35
    s_waitcnt vmcnt(12)
    ds_write_b32 v1, v2 offset:0
    s_add_u32 s35, s68, 54
    v_mov_b32 v2, s35
    s_waitcnt vmcnt(10)
    ds_write_b32 v1, v2 offset:0
    s_add_u32 s35, s68, 56
    v_mov_b32 v2, s35
    s_waitcnt vmcnt(8)
    ds_write_b32 v1, v2 offset:0
    s_add_u32 s35, s68, 58
    v_mov_b32 v2, s35
    s_waitcnt vmcnt(6)
    ds_write_b32 v1, v2 offset:0
    s_add_u32 s35, s68, 60
    v_mov_b32 v2, s35
    s_waitcnt vmcnt(4)
    ds_write_b32 v1, v2 offset:0
    s_add_u32 s35, s68, 62
    v_mov_b32 v2, s35
    s_waitcnt vmcnt(2)
    ds_write_b32 v1, v2 offset:0
    s_add_u32 s35, s68, 64
    v_mov_b32 v2, s35
    s_waitcnt vmcnt(0)
    ds_write_b32 v1, v2 offset:0
    s_endpgm
L_ldya:
    v_mov_b32 v13, 37
    s_mov_b32 m0, 16384
    s_add_u32 s63, s68, 40
S4_11:
    s_waitcnt vmcnt(27)
    buffer_load_dwordx4 v8, s[36:39], s69 offen nt lds
    v_add_u32 v2, s68, v13
    ds_write_b32 v1, v2 offset:0
    s_waitcnt vmcnt(27)
    buffer_load_dwordx4 v9, s[36:39], s69 offen offset:1024 nt lds
    s_waitcnt vmcnt(27)
    buffer_load_dwordx4 v10, s[36:39], s69 offen offset:2048 nt lds
    s_waitcnt vmcnt(27)
    buffer_load_dwordx4 v11, s[36:39], s69 offen offset:3072 nt lds
    s_add_u32 s68, s68, 4
    s_add_u32 m0, m0, 4096
    s_add_u32 s67, s67, 4096
    s_and_b32 s67, s67, 0xffff
    s_or_b32 s69, s61, s67
    s_cmp_lt_u32 s68, s63
    s_cbranch_scc1 S4_11
    s_branch SD_13
SP_12:
    s_sleep 1
SD_13:
    ds_read_b32 v2, v1 offset:28
    s_sub_u32 s34, s34, 1
    s_cbranch_scc1 L_end
    s_waitcnt lgkmcnt(0)
    v_readfirstlane_b32 s35, v2
    s_cmp_lt_u32 s35, 2
    s_cbranch_scc1 SP_12
    s_add_u32 s63, s68, 8
S4_14:
    s_waitcnt vmcnt(27)
    buffer_load_dwordx4 v8, s[36:39], s69 offen nt lds
    v_add_u32 v2, s68, v13
    ds_write_b32 v1, v2 offset:0
    s_waitcnt vmcnt(27)
    buffer_load_dwordx4 v9, s[36:39], s69 offen offset:1024 nt lds
    s_waitcnt vmcnt(27)
    buffer_load_dwordx4 v10, s[36:39], s69 offen offset:2048 nt lds
    s_waitcnt vmcnt(27)
    buffer_load_dwordx4 v11, s[36:39], s69 offen offset:3072 nt lds
    s_add_u32 s68, s68, 4
    s_add_u32 m0, m0, 4096
    s_add_u32 s67, s67, 4096
    s_and_b32 s67, s67, 0xffff
    s_or_b32 s69, s61, s67
    s_cmp_lt_u32 s68, s63
    s_cbranch_scc1 S4_14
    v_mov_b32 v13, 31
    s_add_u32 s63, s68, 64
S4_15:
    s_waitcnt vmcnt(33)
    buffer_load_dwordx4 v12, s[40:43], s69 offen nt lds
    v_add_u32 v2, s68, v13
    ds_write_b32 v1, v2 offset:0
    s_waitcnt vmcnt(33)
    buffer_load_dwordx4 v12, s[40:43], s69 offen offset:1024 nt lds
    s_waitcnt vmcnt(33)
    buffer_load_dwordx4 v12, s[40:43], s69 offen offset:2048 nt lds
    s_waitcnt vmcnt(33)
    buffer_load_dwordx4 v12, s[40:43], s69 offen offset:3072 nt lds
    s_add_u32 s68, s68, 4
    s_add_u32 m0, m0, 4096
    s_add_u32 s67, s67, 4096
    s_and_b32 s67, s67, 0xffff
    s_or_b32 s69, s61, s67
    s_cmp_lt_u32 s68, s63
    s_cbranch_scc1 S4_15
    s_add_u32 s35, s68, 31
    v_mov_b32 v2, s35
    s_waitcnt vmcnt(33)
    ds_write_b32 v1, v2 offset:0
    s_add_u32 s35, s68, 32
    v_mov_b32 v2, s35
    s_waitcnt vmcnt(32)
    ds_write_b32 v1, v2 offset:0
    s_add_u32 s35, s68, 34
    v_mov_b32 v2, s35
    s_waitcnt vmcnt(30)
    ds_write_b32 v1, v2 offset:0
    s_add_u32 s35, s68, 36
    v_mov_b32 v2, s35
    s_waitcnt vmcnt(28)
    ds_write_b32 v1, v2 offset:0
    s_add_u32 s35, s68, 38
    v_mov_b32 v2, s35
    s_waitcnt vmcnt(26)
    ds_write_b32 v1, v2 offset:0
    s_add_u32 s35, s68, 40
    v_mov_b32 v2, s35
    s_waitcnt vmcnt(24)
    ds_write_b32 v1, v2 offset:0
    s_add_u32 s35, s68, 42
    v_mov_b32 v2, s35
    s_waitcnt vmcnt(22)
    ds_write_b32 v1, v2 offset:0
    s_add_u32 s35, s68, 44
    v_mov_b32 v2, s35
    s_waitcnt vmcnt(20)
    ds_write_b32 v1, v2 offset:0
    s_add_u32 s35, s68, 46
    v_mov_b32 v2, s35
    s_waitcnt vmcnt(18)
    ds_write_b32 v1, v2 offset:0
    s_add_u32 s35, s68, 48
    v_mov_b32 v2, s35
    s_waitcnt vmcnt(16)
    ds_write_b32 v1, v2 offset:0
    s_add_u32 s35, s68, 50
    v_mov_b32 v2, s35
    s_waitcnt vmcnt(14)
    ds_write_b32 v1, v2 offset:0
    s_add_u32 s35, s68, 52
    v_mov_b32 v2, s35
    s_waitcnt vmcnt(12)
    ds_write_b32 v1, v2 offset:0
    s_add_u32 s35, s68, 54
    v_mov_b32 v2, s35
    s_waitcnt vmcnt(10)
    ds_write_b32 v1, v2 offset:0
    s_add_u32 s35, s68, 56
    v_mov_b32 v2, s35
    s_waitcnt vmcnt(8)
    ds_write_b32 v1, v2 offset:0
    s_add_u32 s35, s68, 58
    v_mov_b32 v2, s35
    s_waitcnt vmcnt(6)
    ds_write_b32 v1, v2 offset:0
    s_add_u32 s35, s68, 60
    v_mov_b32 v2, s35
    s_waitcnt vmcnt(4)
    ds_write_b32 v1, v2 offset:0
    s_add_u32 s35, s68, 62
    v_mov_b32 v2, s35
    s_waitcnt vmcnt(2)
    ds_write_b32 v1, v2 offset:0
    s_add_u32 s35, s68, 64
    v_mov_b32 v2, s35
    s_waitcnt vmcnt(0)
    ds_write_b32 v1, v2 offset:0
    s_endpgm
L_end:
    s_endpgm
L_other:
    s_load_dwordx8 s[20:27], s[0:1], 64
    s_load_dwordx2 s[28:29], s[0:1], 96
    v_readfirstlane_b32 s3, v0
    v_lshlrev_b32 v1, 2, v0
    v_and_b32 v1, 60, v1
    v_mov_b32 v2, 0
    v_add_u32 v1, 162368, v1
    ds_write_b32 v1, v2
    v_and_b32 v0, 63, v0
    s_lshr_b32 s3, s3, 6
    s_cmp_lg_u32 s3, 2
    s_cbranch_scc1 L_16
    s_cmp_ge_u32 s2, 32
    s_cbranch_scc1 L_16
    s_getpc_b64 s[48:49]
L_pc:
    s_sub_u32 s48, s48, L_pc - gated_mix__sliding_block_cached__swiglu_ffn__decode_kernel
    s_subb_u32 s49, s49, 0
    s_mov_b32 s50, L_codeend - gated_mix__sliding_block_cached__swiglu_ffn__decode_kernel
    s_mov_b32 s51, 0x20000
    s_mov_b32 s44, 8192
    v_lshlrev_b32 v16, 7, v0
    buffer_load_dword v44, v16, s[48:51], 0 offen
    buffer_load_dword v45, v16, s[48:51], s44 offen
L_16:
    v_mov_b32 v1, 162368
    s_and_b32 s62, s2, 7
    s_bfe_u32 s65, s2, 0x10003
    s_and_b32 s30, s2, 15
    s_lshr_b32 s31, s2, 4
    s_mov_b32 s34, 0x2000000
    v_lshrrev_b32 v6, 3, v0
    v_and_b32 v7, 7, v0
    v_lshlrev_b32 v7, 4, v7
    s_lshr_b32 s35, s2, 3
    s_mul_i32 s64, s35, 22
    s_sub_u32 s64, s64, 378
    s_cmp_eq_u32 s35, 31
    s_subb_u32 s64, s64, 0
    s_cmp_ge_u32 s35, 30
    s_cselect_b32 s63, 21, 22
    s_lshr_b32 s35, s31, 1
    s_cmp_eq_u32 s31, 8
    s_cselect_b32 s35, s65, s35
    s_mul_i32 s35, s35, 9
    s_cmp_lt_u32 s31, 9
    s_cselect_b32 s64, s35, s64
    s_cselect_b32 s63, 9, s63
    s_mul_i32 s66, s64, 1821
    s_lshr_b32 s66, s66, 16
    s_lshl_b32 s32, s62, 17
    s_add_u32 s32, s32, 1048576
    s_lshl_b32 s60, s63, 2
    s_add_u32 s60, s60, 64
    s_cmp_eq_u32 s3, 1
    s_cbranch_scc1 L_G
L_roles:
    v_and_b32 v2, 1, v0
    v_cmp_eq_u32 vcc, 1, v2
    v_mov_b32 v3, 0x0c0c0100
    v_mov_b32 v4, 0x01000c0c
    v_cndmask_b32 v3, v3, v4, vcc
    v_mov_b32 v4, 0x0c0c0302
    v_mov_b32 v2, 0x03020c0c
    v_cndmask_b32 v4, v4, v2, vcc
    v_bfe_u32 v2, v0, 1, 2
    v_mov_b32 v5, 0x0c0c0c0c
    v_cmp_eq_u32 vcc, 0, v2
    s_nop 1
    v_cndmask_b32 v8, v5, v3, vcc
    v_cndmask_b32 v9, v5, v4, vcc
    v_cmp_eq_u32 vcc, 1, v2
    s_nop 1
    v_cndmask_b32 v10, v5, v3, vcc
    v_cndmask_b32 v11, v5, v4, vcc
    v_cmp_eq_u32 vcc, 2, v2
    s_nop 1
    v_cndmask_b32 v12, v5, v3, vcc
    v_cndmask_b32 v13, v5, v4, vcc
    v_cmp_eq_u32 vcc, 3, v2
    s_nop 1
    v_cndmask_b32 v14, v5, v3, vcc
    v_cndmask_b32 v15, v5, v4, vcc
    s_waitcnt lgkmcnt(0)
    s_mov_b32 s40, s28
    s_mov_b32 s41, s29
    s_mov_b32 s42, 3145728
    s_mov_b32 s43, 0x20000
    s_sub_u32 s44, s3, 2
    s_min_u32 s45, s44, 7
    s_lshl_b32 s45, s45, 9
    v_lshlrev_b32 v150, 3, v0
    v_add_u32 v150, s45, v150
    v_add_u32 v150, 155648, v150
    v_and_b32 v2, 0x37, v0
    v_lshlrev_b32 v151, 3, v2
    v_bfe_u32 v2, v0, 3, 1
    v_lshl_add_u32 v151, v2, 9, v151
    v_add_u32 v151, 155648, v151
    s_mov_b32 s47, 1069066811
    s_cmp_lt_u32 s3, 6
    s_cbranch_scc1 L_A
    s_barrier
    s_sub_u32 s44, s3, 6
    s_cmp_ge_u32 s44, 2
    s_cbranch_scc1 L_F1
    s_add_u32 s66, s66, s44
    s_mul_i32 s45, s66, 36
    s_max_u32 s48, s45, s64
    s_add_u32 s46, s45, 36
    s_add_u32 s49, s64, s63
    s_min_u32 s49, s49, s46
    s_cmp_ge_u32 s48, s49
    s_cbranch_scc1 L_Fempty
    s_cmp_eq_u32 s49, s46
    s_cselect_b32 s51, 1024, 0
    s_max_u32 s51, s51, 512
    s_sub_u32 s50, s48, s45
    s_cmp_eq_u32 s50, 0
    s_cselect_b32 s51, 0, s51
    s_lshl_b32 s45, s50, 5
    v_lshl_add_u32 v16, v6, 2, s45
    v_add_u32 v16, 147456, v16
    s_sub_u32 s49, s49, s48
    s_sub_u32 s48, s48, s64
    s_lshl_b32 s45, s48, 12
    v_lshl_add_u32 v17, v0, 4, s45
    v_add_u32 v17, 57344, v17
    s_lshl_b32 s48, s48, 2
    s_add_u32 s48, s48, 84
    s_lshl_b32 s49, s49, 2
    s_add_u32 s49, s49, s48
    v_mov_b32 v24, 0
    v_mov_b32 v25, 0
    v_mov_b32 v26, 0
    v_mov_b32 v27, 0
    v_mov_b32 v28, 0
    v_mov_b32 v29, 0
    v_mov_b32 v30, 0
    v_mov_b32 v31, 0
    v_lshrrev_b32 v3, 4, v0
    v_lshl_add_u32 v18, v3, 7, v7
    v_and_b32 v4, 8, v0
    v_cmp_eq_u32 vcc, 0, v4
    v_mov_b32 v3, 1073741824
    s_nop 0
    v_cndmask_b32 v18, v3, v18, vcc
    s_branch SD_19
SP_18:
    s_sleep 1
SD_19:
    ds_read_b32 v2, v1 offset:48
    s_sub_u32 s34, s34, 1
    s_cbranch_scc1 L_end
    s_waitcnt lgkmcnt(0)
    v_readfirstlane_b32 s35, v2
    s_cmp_lt_u32 s35, 1
    s_cbranch_scc1 SP_18
    s_mov_b32 s35, 0
    ds_read_b32 v20, v16
    s_waitcnt lgkmcnt(0)
FG_20:
    v_perm_b32 v32, v20, v20, v8
    v_perm_b32 v33, v20, v20, v10
    v_perm_b32 v34, v20, v20, v12
    v_perm_b32 v35, v20, v20, v14
    v_perm_b32 v36, v20, v20, v9
    v_perm_b32 v37, v20, v20, v11
    v_perm_b32 v38, v20, v20, v13
    v_perm_b32 v39, v20, v20, v15
    v_add_u32 v16, 32, v16
    s_cmp_ge_u32 s35, s48
    s_cbranch_scc1 SK_21
    s_branch SD_23
SP_22:
    s_sleep 1
SD_23:
    ds_read_b32 v2, v1 offset:0
    s_sub_u32 s34, s34, 1
    s_cbranch_scc1 L_end
    s_waitcnt lgkmcnt(0)
    v_readfirstlane_b32 s35, v2
    s_cmp_lt_u32 s35, s48
    s_cbranch_scc1 SP_22
SK_21:
    ds_read_b128 v[48:51], v17 offset:0
    ds_read_b128 v[52:55], v17 offset:1024
    ds_read_b128 v[56:59], v17 offset:2048
    ds_read_b128 v[60:63], v17 offset:3072
    ds_read_b32 v20, v16
    v_add_u32 v17, 4096, v17
    s_add_u32 s48, s48, 4
    s_cmp_lt_u32 s48, s49
    s_waitcnt lgkmcnt(4)
    v_mfma_f32_16x16x32_bf16 v[24:27], v[32:35], v[48:51], v[24:27]
    s_waitcnt lgkmcnt(3)
    v_mfma_f32_16x16x32_bf16 v[24:27], v[36:39], v[52:55], v[24:27]
    s_waitcnt lgkmcnt(2)
    v_mfma_f32_16x16x32_bf16 v[28:31], v[32:35], v[56:59], v[28:31]
    s_waitcnt lgkmcnt(1)
    v_mfma_f32_16x16x32_bf16 v[28:31], v[36:39], v[60:63], v[28:31]
    s_waitcnt lgkmcnt(0)
    s_cbranch_scc1 FG_20
    v_mov_b32 v2, 1
    s_mov_b64 exec, 1
    ds_add_u32 v1, v2 offset:28
    s_mov_b64 exec, -1
    s_cmp_ge_u32 s31, 8
    s_cbranch_scc1 PD_17
    s_branch SD_25
SP_24:
    s_sleep 1
SD_25:
    ds_read_b32 v2, v1 offset:12
    s_sub_u32 s34, s34, 1
    s_cbranch_scc1 L_end
    s_waitcnt lgkmcnt(0)
    v_readfirstlane_b32 s35, v2
    s_cmp_lt_u32 s35, 1
    s_cbranch_scc1 SP_24
    ds_read_b32 v2, v1 offset:8
    s_waitcnt lgkmcnt(0)
    v_readfirstlane_b32 s59, v2
    s_nop 0
    s_and_b32 s33, s59, 0xfffffff0
    s_lshl_b32 s45, s65, 3
    s_add_u32 s45, s45, s31
    s_lshl_b32 s45, s45, 10
    s_add_u32 s52, s32, s45
    v_lshlrev_b32 v16, 4, v0
    v_add_u32 v16, 151552, v16
    v_permlane32_swap_b32 v24, v26
    v_permlane32_swap_b32 v25, v27
    s_nop 1
    v_add_f32_dpp v24, v26, v24 row_ror:8 row_mask:0xf bank_mask:0xf
    v_add_f32_dpp v26, v27, v25 row_ror:8 row_mask:0xf bank_mask:0xf
    v_mov_b32 v25, s33
    v_mov_b32 v27, s33
    v_permlane32_swap_b32 v28, v30
    v_permlane32_swap_b32 v29, v31
    s_nop 1
    v_add_f32_dpp v28, v30, v28 row_ror:8 row_mask:0xf bank_mask:0xf
    v_add_f32_dpp v30, v31, v29 row_ror:8 row_mask:0xf bank_mask:0xf
    v_mov_b32 v29, s33
    v_mov_b32 v31, s33
    ds_write_b128 v16, v[24:27]
    ds_write_b128 v16, v[28:31] offset:1024
    s_waitcnt lgkmcnt(0)
    buffer_store_dwordx4 v[24:27], v18, s[40:43], s52 offen
    buffer_store_dwordx4 v[28:31], v18, s[40:43], s52 offen offset:512
    v_mov_b32 v2, 1
    ds_write_b32 v1, v2 offset:44
    s_branch L_F1
PD_17:
    s_branch SD_27
SP_26:
    s_sleep 2
SD_27:
    ds_read_b32 v2, v1 offset:4
    s_sub_u32 s34, s34, 1
    s_cbranch_scc1 L_end
    s_waitcnt lgkmcnt(0)
    v_readfirstlane_b32 s35, v2
    s_cmp_lt_u32 s35, 1
    s_cbranch_scc1 SP_26
    s_mov_b32 s58, s35
    s_cmp_eq_u32 s35, 1
    s_cselect_b32 s57, 1048576, 0
    s_add_u32 s57, s57, s32
    ds_read_b32 v2, v1 offset:8
    s_waitcnt lgkmcnt(0)
    v_readfirstlane_b32 s59, v2
    s_nop 0
    s_and_b32 s33, s59, 0xfffffff0
    s_add_u32 s51, s51, s57
    s_add_u32 s51, s51, 32768
    s_mul_i32 s46, s66, 1536
    s_add_u32 s46, s46, s51
    s_add_u32 s45, s66, 13
    s_cmp_ge_u32 s66, 5
    s_cselect_b32 s48, 9, 0
    s_sub_u32 s45, s45, s48
    s_mul_i32 s45, s45, 1536
    s_add_u32 s45, s45, s51
    v_permlane32_swap_b32 v24, v26
    v_permlane32_swap_b32 v25, v27
    s_nop 1
    v_add_f32_dpp v24, v26, v24 row_ror:8 row_mask:0xf bank_mask:0xf
    v_add_f32_dpp v26, v27, v25 row_ror:8 row_mask:0xf bank_mask:0xf
    v_mov_b32 v25, s33
    v_mov_b32 v27, s33
    v_permlane32_swap_b32 v28, v30
    v_permlane32_swap_b32 v29, v31
    s_nop 1
    v_add_f32_dpp v28, v30, v28 row_ror:8 row_mask:0xf bank_mask:0xf
    v_add_f32_dpp v30, v31, v29 row_ror:8 row_mask:0xf bank_mask:0xf
    v_mov_b32 v29, s33
    v_mov_b32 v31, s33
    s_cmp_eq_u32 s58, 1
    s_cbranch_scc1 SAFE_28
    buffer_store_dwordx4 v[24:27], v18, s[40:43], s46 offen
    buffer_store_dwordx4 v[28:31], v18, s[40:43], s45 offen
BACK_29:
    s_branch L_F1
L_Fempty:
    v_mov_b32 v2, 1
    s_mov_b64 exec, 1
    ds_add_u32 v1, v2 offset:28
    s_mov_b64 exec, -1
L_F1:
    s_cmp_ge_u32 s31, 9
    s_cbranch_scc1 FEND_30
    s_branch SD_32
SP_31:
    s_sleep 2
SD_32:
    ds_read_b32 v2, v1 offset:4
    s_sub_u32 s34, s34, 1
    s_cbranch_scc1 L_end
    s_waitcnt lgkmcnt(0)
    v_readfirstlane_b32 s35, v2
    s_cmp_lt_u32 s35, 1
    s_cbranch_scc1 SP_31
    s_mov_b32 s58, s35
    s_cmp_eq_u32 s35, 1
    s_cselect_b32 s57, 1048576, 0
    s_add_u32 s57, s57, s32
    ds_read_b32 v2, v1 offset:8
    s_waitcnt lgkmcnt(0)
    v_readfirstlane_b32 s59, v2
    s_nop 0
    s_and_b32 s33, s59, 0xfffffff0
    v_and_b32 v2, 31, v0
    v_lshlrev_b32 v16, 4, v2
    v_lshrrev_b32 v2, 5, v0
    v_mul_u32_u24 v2, 9*1536, v2
    v_add_u32 v16, v16, v2
    s_lshl_b32 s45, s65, 2
    s_add_u32 s45, s45, s44
    s_bitcmp1_b32 151, s45
    s_cselect_b32 s54, -1, 0
    s_bitcmp1_b32 372, s45
    s_cselect_b32 s55, -1, 0
    v_add_u32 v2, 512, v16
    v_cndmask_b32 v21, v16, v2, s[54:55]
    s_mul_i32 s52, s45, 1536
    s_add_u32 s52, s52, s57
    s_add_u32 s52, s52, 32768
    v_bfe_u32 v2, v0, 3, 1
    v_lshl_add_u32 v19, v2, 3, v7
    v_bfe_u32 v2, v0, 4, 1
    v_lshl_add_u32 v19, v2, 2, v19
    s_lshl_b32 s46, s44, 7
    s_add_u32 s46, s46, 161536
    v_add_u32 v19, s46, v19
    v_lshl_add_u32 v20, v6, 4, s46
    s_lshl_b32 s49, s65, 2
    s_cmp_eq_u32 s45, 4
    s_cselect_b32 s46, 3, 7
    s_cselect_b32 s48, s49, 0
    v_and_b32 v2, s46, v6
    v_or_b32 v2, s48, v2
    v_lshl_add_u32 v17, v2, 10, v7
    s_lshl_b32 s45, s45, 13
    s_mul_i32 s49, s65, 288*128
    s_sub_u32 s45, s45, s49
    v_add_u32 v17, s45, v17
    s_add_u32 s53, s45, 8192
    s_lshr_b32 s53, s53, 10
    s_min_u32 s53, s53, 36
    s_add_u32 s53, s53, 228
    v_and_b32 v3, 7, v0
    v_and_b32 v2, s46, v3
    v_or_b32 v2, s48, v2
    v_cmp_eq_u32 s[50:51], v2, v3
    v_mov_b32 v5, 162304
    ds_read_b32 v18, v5 offset:4
    s_waitcnt vmcnt(0)
    s_branch SD_34
SP_33:
    s_sleep 2
SD_34:
    ds_read_b32 v2, v1 offset:0
    s_sub_u32 s34, s34, 1
    s_cbranch_scc1 L_end
    s_waitcnt lgkmcnt(0)
    v_readfirstlane_b32 s35, v2
    s_cmp_lt_u32 s35, 226
    s_cbranch_scc1 SP_33
CR_35:
    buffer_load_dwordx4 v[32:35], v16, s[40:43], s52 offen sc1
    buffer_load_dwordx4 v[36:39], v16, s[40:43], s52 offen offset:1024 sc1
    buffer_load_dwordx4 v[40:43], v21, s[40:43], s52 offen sc1
    s_sub_u32 s34, s34, 4
    s_cbranch_scc1 L_end
    s_waitcnt vmcnt(0)
    v_cmpx_eq_u32 vcc, s33, v33
    v_cmpx_eq_u32 vcc, s33, v35
    v_cmpx_eq_u32 vcc, s33, v37
    v_cmpx_eq_u32 vcc, s33, v39
    v_cmpx_eq_u32 vcc, s33, v41
    v_cmpx_eq_u32 vcc, s33, v43
    s_cmp_eq_u64 exec, -1
    s_mov_b64 exec, -1
    s_cbranch_scc0 CR_35
    v_cndmask_b32 v40, 0, v40, s[54:55]
    v_cndmask_b32 v42, 0, v42, s[54:55]
    v_add_f32 v24, v32, v36
    v_add_f32 v25, v34, v38
    v_add_f32 v24, v24, v40
    v_add_f32 v25, v25, v42
    v_cvt_pk_bf16_f32 v24, v24, v25
    v_mov_b32 v26, v24
    s_nop 1
    v_permlane32_swap_b32 v24, v26
    s_nop 0
    v_lshlrev_b32 v28, 16, v24
    v_and_b32 v29, 0xffff0000, v24
    v_mul_f32 v30, s47, v28
    v_mul_f32 v31, s47, v29
    v_exp_f32 v30, -v30
    v_exp_f32 v31, -v31
    v_lshlrev_b32 v27, 16, v26
    v_and_b32 v26, 0xffff0000, v26
    v_add_f32 v30, 1.0, v30
    v_add_f32 v31, 1.0, v31
    v_rcp_f32 v30, v30
    v_rcp_f32 v31, v31
    s_nop 0
    v_mul_f32 v28, v28, v30
    v_mul_f32 v29, v29, v31
    v_cvt_pk_bf16_f32 v24, v28, v29
    v_lshlrev_b32 v28, 16, v24
    v_and_b32 v29, 0xffff0000, v24
    v_mul_f32 v28, v28, v27
    v_mul_f32 v29, v29, v26
    v_cvt_pk_bf16_f32 v24, v28, v29
    v_cndmask_b32 v24, 0, v24, s[50:51]
    ds_write_b32 v19, v24
    ds_read_b128 v[28:31], v20
    s_waitcnt lgkmcnt(0)
    v_perm_b32 v64, v28, v28, v8
    v_perm_b32 v65, v28, v28, v10
    v_perm_b32 v66, v28, v28, v12
    v_perm_b32 v67, v28, v28, v14
    v_perm_b32 v68, v28, v28, v9
    v_perm_b32 v69, v28, v28, v11
    v_perm_b32 v70, v28, v28, v13
    v_perm_b32 v71, v28, v28, v15
    v_perm_b32 v72, v29, v29, v8
    v_perm_b32 v73, v29, v29, v10
    v_perm_b32 v74, v29, v29, v12
    v_perm_b32 v75, v29, v29, v14
    v_perm_b32 v76, v29, v29, v9
    v_perm_b32 v77, v29, v29, v11
    v_perm_b32 v78, v29, v29, v13
    v_perm_b32 v79, v29, v29, v15
    v_perm_b32 v80, v30, v30, v8
    v_perm_b32 v81, v30, v30, v10
    v_perm_b32 v82, v30, v30, v12
    v_perm_b32 v83, v30, v30, v14
    v_perm_b32 v84, v30, v30, v9
    v_perm_b32 v85, v30, v30, v11
    v_perm_b32 v86, v30, v30, v13
    v_perm_b32 v87, v30, v30, v15
    v_perm_b32 v88, v31, v31, v8
    v_perm_b32 v89, v31, v31, v10
    v_perm_b32 v90, v31, v31, v12
    v_perm_b32 v91, v31, v31, v14
    v_perm_b32 v92, v31, v31, v9
    v_perm_b32 v93, v31, v31, v11
    v_perm_b32 v94, v31, v31, v13
    v_perm_b32 v95, v31, v31, v15
    s_branch SD_37
SP_36:
    s_sleep 1
SD_37:
    ds_read_b32 v2, v1 offset:0
    s_sub_u32 s34, s34, 1
    s_cbranch_scc1 L_end
    s_waitcnt lgkmcnt(0)
    v_readfirstlane_b32 s35, v2
    s_cmp_lt_u32 s35, s53
    s_cbranch_scc1 SP_36
    ds_read_b128 v[112:115], v17 offset:0
    ds_read_b128 v[116:119], v17 offset:128
    ds_read_b128 v[120:123], v17 offset:256
    ds_read_b128 v[124:127], v17 offset:384
    ds_read_b128 v[128:131], v17 offset:512
    ds_read_b128 v[132:135], v17 offset:640
    ds_read_b128 v[136:139], v17 offset:768
    ds_read_b128 v[140:143], v17 offset:896
    s_waitcnt lgkmcnt(7)
    v_mfma_f32_16x16x32_bf16 v[24:27], v[64:67], v[112:115], 0
    s_waitcnt lgkmcnt(6)
    v_mfma_f32_16x16x32_bf16 v[24:27], v[68:71], v[116:119], v[24:27]
    s_waitcnt lgkmcnt(5)
    v_mfma_f32_16x16x32_bf16 v[24:27], v[72:75], v[120:123], v[24:27]
    s_waitcnt lgkmcnt(4)
    v_mfma_f32_16x16x32_bf16 v[24:27], v[76:79], v[124:127], v[24:27]
    s_waitcnt lgkmcnt(3)
    v_mfma_f32_16x16x32_bf16 v[24:27], v[80:83], v[128:131], v[24:27]
    s_waitcnt lgkmcnt(2)
    v_mfma_f32_16x16x32_bf16 v[24:27], v[84:87], v[132:135], v[24:27]
    s_waitcnt lgkmcnt(1)
    v_mfma_f32_16x16x32_bf16 v[24:27], v[88:91], v[136:139], v[24:27]
    s_waitcnt lgkmcnt(0)
    v_mfma_f32_16x16x32_bf16 v[24:27], v[92:95], v[140:143], v[24:27]
    s_lshl_b32 s45, s44, 1
    s_add_u32 s45, s45, 1
    s_nop 5
    v_mul_f32 v24, v18, v24
    v_mul_f32 v25, v18, v25
    v_mul_f32 v26, v18, v26
    v_mul_f32 v27, v18, v27
    s_cmp_lt_u32 s44, 4
    s_cbranch_scc1 L_A3
    v_lshrrev_b32 v3, 4, v0
    v_lshl_add_u32 v148, v3, 11, v7
    v_and_b32 v4, 8, v0
    v_cmp_eq_u32 vcc, 0, v4
    v_mov_b32 v3, 1073741824
    s_nop 0
    v_cndmask_b32 v148, v3, v148, vcc
    v_mov_b32 v149, 1
    s_lshl_b32 s46, s31, 13
    s_lshl_b32 s35, s30, 7
    s_add_u32 s46, s46, s35
    s_add_u32 s46, s46, 524288
L_fin:
    v_permlane32_swap_b32 v24, v26
    v_permlane32_swap_b32 v25, v27
    s_nop 1
    v_add_f32_dpp v24, v26, v24 row_ror:8 row_mask:0xf bank_mask:0xf
    v_add_f32_dpp v25, v27, v25 row_ror:8 row_mask:0xf bank_mask:0xf
    s_cmp_eq_u32 s3, 9
    s_cbranch_scc1 L_fin9
    ds_write_b64 v150, v[24:25]
    s_mov_b64 exec, 1
    ds_add_u32 v1, v149 offset:32
    s_mov_b64 exec, -1
    s_branch NL_38
L_finl:
    ds_read_b32 v4, v1 offset:32
    ds_read_b64 v[152:153], v151 offset:0
    ds_read_b64 v[154:155], v151 offset:1024
    ds_read_b64 v[156:157], v151 offset:2048
    ds_read_b64 v[158:159], v151 offset:3072
    s_sub_u32 s34, s34, 1
    s_cbranch_scc1 L_end
L_fin9:
    s_waitcnt lgkmcnt(0)
    v_readfirstlane_b32 s35, v4
    v_add_f32 v152, v152, v154
    v_add_f32 v153, v153, v155
    s_cmp_lt_u32 s35, 8
    s_cbranch_scc1 L_finl
    v_add_f32 v156, v156, v158
    v_add_f32 v157, v157, v159
    v_mov_b32 v27, s33
    v_add_f32 v152, v152, v156
    v_add_f32 v153, v153, v157
    v_add_f32 v24, v24, v152
    v_add_f32 v26, v25, v153
    v_add_f32_dpp v24, v152, v24 row_ror:8 row_mask:0xf bank_mask:0xf
    v_add_f32_dpp v26, v153, v26 row_ror:8 row_mask:0xf bank_mask:0xf
    v_mov_b32 v25, s33
    buffer_store_dwordx4 v[24:27], v148, s[40:43], s46 offen sc1
NL_38:
    s_endpgm
FEND_30:
    s_endpgm
L_A:
    s_lshl_b32 s45, s44, 12
    v_and_b32 v2, 15, v0
    v_lshrrev_b32 v3, 4, v0
    v_xor_b32 v4, v2, v3
    v_lshlrev_b32 v4, 4, v4
    v_lshl_add_u32 v4, v2, 8, v4
    v_add_u32 v16, s45, v4
    v_xor_b32 v17, 64, v16
    v_xor_b32 v18, 128, v16
    v_xor_b32 v19, 192, v16
    v_lshlrev_b32 v20, 10, v3
    v_lshl_add_u32 v20, v2, 4, v20
    v_add_u32 v20, s45, v20
    v_add_u32 v20, 65536, v20
    v_bfe_u32 v21, v0, 3, 1
    v_lshlrev_b32 v21, 8, v21
    v_lshl_add_u32 v21, v3, 4, v21
    v_add_u32 v21, 161024, v21
    v_lshrrev_b32 v2, 5, v0
    v_lshlrev_b32 v144, 13, v2
    v_bfe_u32 v3, v0, 2, 2
    v_lshl_add_u32 v144, v3, 11, v144
    v_and_b32 v3, 3, v0
    v_lshl_add_u32 v144, v3, 8, v144
    v_bfe_u32 v3, v0, 4, 1
    v_lshl_add_u32 v144, v3, 7, v144
    v_lshlrev_b32 v145, 8, v2
    v_and_b32 v3, 31, v0
    v_cmp_eq_u32 vcc, 0, v3
    v_mov_b32 v3, 1073741824
    v_lshlrev_b32 v146, 4, v2
    v_cndmask_b32 v145, v3, v145, vcc
    v_add_u32 v146, 160768, v146
    v_lshlrev_b32 v147, 4, v0
    v_add_u32 v147, 151552, v147
    s_lshl_b32 s45, s44, 10
    v_add_u32 v148, s45, v147
    v_bfe_u32 v149, v0, 3, 1
    v_lshlrev_b32 v149, 4, v149
    v_add_u32 v149, 160768, v149
    s_lshl_b32 s45, s44, 2
    v_add_u32 v152, s45, v149
    s_mov_b32 s46, 1035273459
    s_barrier
    s_waitcnt vmcnt(0)
    s_branch SD_40
SP_39:
    s_sleep 2
SD_40:
    ds_read_b32 v2, v1 offset:4
    s_sub_u32 s34, s34, 1
    s_cbranch_scc1 L_end
    s_waitcnt lgkmcnt(0)
    v_readfirstlane_b32 s35, v2
    s_cmp_lt_u32 s35, 1
    s_cbranch_scc1 SP_39
    ds_read_b128 v[96:99], v21 offset:0
    ds_read_b128 v[100:103], v21 offset:64
    ds_read_b128 v[104:107], v21 offset:128
    ds_read_b128 v[108:111], v21 offset:192
    s_mov_b32 s58, s35
    s_cmp_eq_u32 s35, 1
    s_cselect_b32 s57, 1048576, 0
    s_add_u32 s57, s57, s32
    ds_read_b32 v2, v1 offset:8
    s_waitcnt lgkmcnt(0)
    v_readfirstlane_b32 s59, v2
    s_nop 0
    s_and_b32 s33, s59, 0xfffffff0
    s_lshl_b32 s52, s65, 14
    s_add_u32 s52, s52, s57
    s_add_u32 s52, s52, 65536
    s_lshl_b32 s54, s65, 9
    s_add_u32 s54, s54, s57
    s_add_u32 s54, s54, 20480
    s_lshr_b32 s35, s31, 3
    s_lshl_b32 s35, s35, 10
    s_add_u32 s48, s52, s35
    s_and_b32 s35, s31, 7
    s_lshl_b32 s35, s35, 4
    s_add_u32 s48, s48, s35
    s_lshl_b32 s35, s31, 4
    s_add_u32 s49, s54, s35
    s_mov_b32 s53, 0
    s_lshl_b32 s55, s44, 2
    s_add_u32 s55, s55, s60
    v_mov_b32 v161, s33
    v_mov_b32 v163, s33
    v_mov_b32 v165, s33
    v_mov_b32 v167, s33
    s_add_u32 s56, s55, 4
    s_cmp_ge_u32 s53, s56
    s_cbranch_scc1 SC_41
    s_branch SD_43
SP_42:
    s_sleep 1
SD_43:
    ds_read_b32 v2, v1 offset:0
    s_sub_u32 s34, s34, 1
    s_cbranch_scc1 L_end
    s_waitcnt lgkmcnt(0)
    v_readfirstlane_b32 s35, v2
    s_cmp_lt_u32 s35, s56
    s_cbranch_scc1 SP_42
    s_mov_b32 s53, s35
SC_41:
    ds_read_b128 v[32:35], v16 offset:0
    ds_read_b128 v[36:39], v17 offset:0
    ds_read_b128 v[40:43], v18 offset:0
    ds_read_b128 v[44:47], v19 offset:0
    s_waitcnt lgkmcnt(3)
    v_mfma_f32_16x16x32_bf16 v[112:115], v[32:35], v[96:99], 0
    s_waitcnt lgkmcnt(2)
    v_mfma_f32_16x16x32_bf16 v[112:115], v[36:39], v[100:103], v[112:115]
    s_waitcnt lgkmcnt(1)
    v_mfma_f32_16x16x32_bf16 v[112:115], v[40:43], v[104:107], v[112:115]
    s_waitcnt lgkmcnt(0)
    v_mfma_f32_16x16x32_bf16 v[112:115], v[44:47], v[108:111], v[112:115]
    s_nop 7
    v_cvt_pk_bf16_f32 v2, v112, v113
    v_cvt_pk_bf16_f32 v3, v114, v115
    v_lshlrev_b32 v112, 16, v2
    v_and_b32 v113, 0xffff0000, v2
    v_lshlrev_b32 v114, 16, v3
    v_and_b32 v115, 0xffff0000, v3
    v_mul_f32 v112, s46, v112
    v_mul_f32 v113, s46, v113
    v_mul_f32 v114, s46, v114
    v_mul_f32 v115, s46, v115
    v_cvt_pk_bf16_f32 v2, v112, v113
    v_cvt_pk_bf16_f32 v3, v114, v115
    v_lshlrev_b32 v112, 16, v2
    v_and_b32 v113, 0xffff0000, v2
    v_lshlrev_b32 v114, 16, v3
    v_and_b32 v115, 0xffff0000, v3
    v_max_f32 v22, v112, v113
    v_max3_f32 v22, v22, v114, v115
    s_add_u32 s56, s55, 20
    s_cmp_ge_u32 s53, s56
    s_cbranch_scc1 SC_44
    s_branch SD_46
SP_45:
    s_sleep 1
SD_46:
    ds_read_b32 v2, v1 offset:0
    s_sub_u32 s34, s34, 1
    s_cbranch_scc1 L_end
    s_waitcnt lgkmcnt(0)
    v_readfirstlane_b32 s35, v2
    s_cmp_lt_u32 s35, s56
    s_cbranch_scc1 SP_45
    s_mov_b32 s53, s35
SC_44:
    ds_read_b128 v[32:35], v16 offset:16384
    ds_read_b128 v[36:39], v17 offset:16384
    ds_read_b128 v[40:43], v18 offset:16384
    ds_read_b128 v[44:47], v19 offset:16384
    s_waitcnt lgkmcnt(3)
    v_mfma_f32_16x16x32_bf16 v[116:119], v[32:35], v[96:99], 0
    s_waitcnt lgkmcnt(2)
    v_mfma_f32_16x16x32_bf16 v[116:119], v[36:39], v[100:103], v[116:119]
    s_waitcnt lgkmcnt(1)
    v_mfma_f32_16x16x32_bf16 v[116:119], v[40:43], v[104:107], v[116:119]
    s_waitcnt lgkmcnt(0)
    v_mfma_f32_16x16x32_bf16 v[116:119], v[44:47], v[108:111], v[116:119]
    s_nop 7
    v_cvt_pk_bf16_f32 v2, v116, v117
    v_cvt_pk_bf16_f32 v3, v118, v119
    v_lshlrev_b32 v116, 16, v2
    v_and_b32 v117, 0xffff0000, v2
    v_lshlrev_b32 v118, 16, v3
    v_and_b32 v119, 0xffff0000, v3
    v_mul_f32 v116, s46, v116
    v_mul_f32 v117, s46, v117
    v_mul_f32 v118, s46, v118
    v_mul_f32 v119, s46, v119
    v_cvt_pk_bf16_f32 v2, v116, v117
    v_cvt_pk_bf16_f32 v3, v118, v119
    v_lshlrev_b32 v116, 16, v2
    v_and_b32 v117, 0xffff0000, v2
    v_lshlrev_b32 v118, 16, v3
    v_and_b32 v119, 0xffff0000, v3
    v_max3_f32 v22, v22, v116, v117
    v_max3_f32 v22, v22, v118, v119
    s_add_u32 s56, s55, 36
    s_cmp_ge_u32 s53, s56
    s_cbranch_scc1 SC_47
    s_branch SD_49
SP_48:
    s_sleep 1
SD_49:
    ds_read_b32 v2, v1 offset:0
    s_sub_u32 s34, s34, 1
    s_cbranch_scc1 L_end
    s_waitcnt lgkmcnt(0)
    v_readfirstlane_b32 s35, v2
    s_cmp_lt_u32 s35, s56
    s_cbranch_scc1 SP_48
    s_mov_b32 s53, s35
SC_47:
    ds_read_b128 v[32:35], v16 offset:32768
    ds_read_b128 v[36:39], v17 offset:32768
    ds_read_b128 v[40:43], v18 offset:32768
    ds_read_b128 v[44:47], v19 offset:32768
    s_waitcnt lgkmcnt(3)
    v_mfma_f32_16x16x32_bf16 v[120:123], v[32:35], v[96:99], 0
    s_waitcnt lgkmcnt(2)
    v_mfma_f32_16x16x32_bf16 v[120:123], v[36:39], v[100:103], v[120:123]
    s_waitcnt lgkmcnt(1)
    v_mfma_f32_16x16x32_bf16 v[120:123], v[40:43], v[104:107], v[120:123]
    s_waitcnt lgkmcnt(0)
    v_mfma_f32_16x16x32_bf16 v[120:123], v[44:47], v[108:111], v[120:123]
    s_nop 7
    v_cvt_pk_bf16_f32 v2, v120, v121
    v_cvt_pk_bf16_f32 v3, v122, v123
    v_lshlrev_b32 v120, 16, v2
    v_and_b32 v121, 0xffff0000, v2
    v_lshlrev_b32 v122, 16, v3
    v_and_b32 v123, 0xffff0000, v3
    v_mul_f32 v120, s46, v120
    v_mul_f32 v121, s46, v121
    v_mul_f32 v122, s46, v122
    v_mul_f32 v123, s46, v123
    v_cvt_pk_bf16_f32 v2, v120, v121
    v_cvt_pk_bf16_f32 v3, v122, v123
    v_lshlrev_b32 v120, 16, v2
    v_and_b32 v121, 0xffff0000, v2
    v_lshlrev_b32 v122, 16, v3
    v_and_b32 v123, 0xffff0000, v3
    v_max3_f32 v22, v22, v120, v121
    v_max3_f32 v22, v22, v122, v123
    s_add_u32 s56, s55, 52
    s_cmp_ge_u32 s53, s56
    s_cbranch_scc1 SC_50
    s_branch SD_52
SP_51:
    s_sleep 1
SD_52:
    ds_read_b32 v2, v1 offset:0
    s_sub_u32 s34, s34, 1
    s_cbranch_scc1 L_end
    s_waitcnt lgkmcnt(0)
    v_readfirstlane_b32 s35, v2
    s_cmp_lt_u32 s35, s56
    s_cbranch_scc1 SP_51
    s_mov_b32 s53, s35
SC_50:
    ds_read_b128 v[32:35], v16 offset:49152
    ds_read_b128 v[36:39], v17 offset:49152
    ds_read_b128 v[40:43], v18 offset:49152
    ds_read_b128 v[44:47], v19 offset:49152
    s_waitcnt lgkmcnt(3)
    v_mfma_f32_16x16x32_bf16 v[124:127], v[32:35], v[96:99], 0
    s_waitcnt lgkmcnt(2)
    v_mfma_f32_16x16x32_bf16 v[124:127], v[36:39], v[100:103], v[124:127]
    s_waitcnt lgkmcnt(1)
    v_mfma_f32_16x16x32_bf16 v[124:127], v[40:43], v[104:107], v[124:127]
    s_waitcnt lgkmcnt(0)
    v_mfma_f32_16x16x32_bf16 v[124:127], v[44:47], v[108:111], v[124:127]
    v_mov_b32 v2, 1
    s_mov_b64 exec, 1
    ds_add_u32 v1, v2 offset:16
    s_mov_b64 exec, -1
    s_nop 3
    v_cvt_pk_bf16_f32 v2, v124, v125
    v_cvt_pk_bf16_f32 v3, v126, v127
    v_lshlrev_b32 v124, 16, v2
    v_and_b32 v125, 0xffff0000, v2
    v_lshlrev_b32 v126, 16, v3
    v_and_b32 v127, 0xffff0000, v3
    v_mul_f32 v124, s46, v124
    v_mul_f32 v125, s46, v125
    v_mul_f32 v126, s46, v126
    v_mul_f32 v127, s46, v127
    v_cvt_pk_bf16_f32 v2, v124, v125
    v_cvt_pk_bf16_f32 v3, v126, v127
    v_lshlrev_b32 v124, 16, v2
    v_and_b32 v125, 0xffff0000, v2
    v_lshlrev_b32 v126, 16, v3
    v_and_b32 v127, 0xffff0000, v3
    v_max3_f32 v22, v22, v124, v125
    v_max3_f32 v22, v22, v126, v127
    v_mov_b32 v2, v22
    s_nop 1
    v_permlane32_swap_b32 v2, v22
    s_nop 0
    v_max_f32 v22, v2, v22
    v_mov_b32 v2, v22
    s_nop 1
    v_permlane16_swap_b32 v2, v22
    s_nop 0
    v_max_f32 v22, v2, v22
    ds_write_b32 v152, v22
    v_mov_b32 v2, 1
    s_mov_b64 exec, 1
    ds_add_u32 v1, v2 offset:36
    s_mov_b64 exec, -1
MX_53:
    ds_read_b32 v2, v1 offset:36
    ds_read_b128 v[28:31], v149
    ds_read_b128 v[156:159], v146
    s_sub_u32 s34, s34, 1
    s_cbranch_scc1 L_end
    s_waitcnt lgkmcnt(0)
    v_readfirstlane_b32 s35, v2
    s_cmp_lt_u32 s35, 4
    s_cbranch_scc1 MX_53
    v_max_f32 v22, v28, v29
    v_max3_f32 v22, v22, v30, v31
    v_sub_f32 v112, v112, v22
    v_sub_f32 v113, v113, v22
    v_sub_f32 v114, v114, v22
    v_sub_f32 v115, v115, v22
    v_sub_f32 v116, v116, v22
    v_sub_f32 v117, v117, v22
    v_sub_f32 v118, v118, v22
    v_sub_f32 v119, v119, v22
    v_sub_f32 v120, v120, v22
    v_sub_f32 v121, v121, v22
    v_sub_f32 v122, v122, v22
    v_sub_f32 v123, v123, v22
    v_sub_f32 v124, v124, v22
    v_sub_f32 v125, v125, v22
    v_sub_f32 v126, v126, v22
    v_sub_f32 v127, v127, v22
    v_mul_f32 v112, s47, v112
    v_mul_f32 v113, s47, v113
    v_mul_f32 v114, s47, v114
    v_mul_f32 v115, s47, v115
    v_mul_f32 v116, s47, v116
    v_mul_f32 v117, s47, v117
    v_mul_f32 v118, s47, v118
    v_mul_f32 v119, s47, v119
    v_mul_f32 v120, s47, v120
    v_mul_f32 v121, s47, v121
    v_mul_f32 v122, s47, v122
    v_mul_f32 v123, s47, v123
    v_mul_f32 v124, s47, v124
    v_mul_f32 v125, s47, v125
    v_mul_f32 v126, s47, v126
    v_mul_f32 v127, s47, v127
    v_exp_f32 v112, v112
    v_exp_f32 v113, v113
    v_exp_f32 v114, v114
    v_exp_f32 v115, v115
    v_exp_f32 v116, v116
    v_exp_f32 v117, v117
    v_exp_f32 v118, v118
    v_exp_f32 v119, v119
    v_exp_f32 v120, v120
    v_exp_f32 v121, v121
    v_exp_f32 v122, v122
    v_exp_f32 v123, v123
    v_exp_f32 v124, v124
    v_exp_f32 v125, v125
    v_exp_f32 v126, v126
    v_exp_f32 v127, v127
    v_add_f32 v23, v112, v113
    v_add_f32 v28, v114, v115
    v_add_f32 v23, v23, v116
    v_add_f32 v28, v28, v117
    v_add_f32 v23, v23, v118
    v_add_f32 v28, v28, v119
    v_add_f32 v23, v23, v120
    v_add_f32 v28, v28, v121
    v_add_f32 v23, v23, v122
    v_add_f32 v28, v28, v123
    v_add_f32 v23, v23, v124
    v_add_f32 v28, v28, v125
    v_add_f32 v23, v23, v126
    v_add_f32 v28, v28, v127
    v_add_f32 v23, v23, v28
    v_mov_b32 v2, v23
    s_nop 1
    v_permlane32_swap_b32 v2, v23
    s_nop 0
    v_add_f32 v23, v2, v23
    v_mov_b32 v2, v23
    s_nop 1
    v_permlane16_swap_b32 v2, v23
    s_nop 0
    v_add_f32 v23, v2, v23
    ds_write_b32 v152, v23 offset:32
    v_mov_b32 v2, 1
    s_mov_b64 exec, 1
    ds_add_u32 v1, v2 offset:40
    s_mov_b64 exec, -1
    s_cmp_lg_u32 s44, 3
    s_cbranch_scc1 NS_54
    v_max_f32 v160, v156, v157
    v_max3_f32 v160, v160, v158, v159
LL_55:
    ds_read_b32 v2, v1 offset:40
    ds_read_b128 v[28:31], v146 offset:32
    s_sub_u32 s34, s34, 1
    s_cbranch_scc1 L_end
    s_waitcnt lgkmcnt(0)
    v_readfirstlane_b32 s35, v2
    s_cmp_lt_u32 s35, 4
    s_cbranch_scc1 LL_55
    v_add_f32 v28, v28, v29
    v_add_f32 v30, v30, v31
    v_add_f32 v162, v28, v30
    v_rcp_f32 v153, v162
    s_cmp_eq_u32 s58, 1
    s_cbranch_scc1 SAFE_56
    buffer_store_dwordx4 v[160:163], v145, s[40:43], s49 offen
BACK_57:
NS_54:
    s_add_u32 s56, s55, 68
    s_cmp_ge_u32 s53, s56
    s_cbranch_scc1 SC_58
    s_branch SD_60
SP_59:
    s_sleep 1
SD_60:
    ds_read_b32 v2, v1 offset:0
    s_sub_u32 s34, s34, 1
    s_cbranch_scc1 L_end
    s_waitcnt lgkmcnt(0)
    v_readfirstlane_b32 s35, v2
    s_cmp_lt_u32 s35, s56
    s_cbranch_scc1 SP_59
    s_mov_b32 s53, s35
SC_58:
    ds_read_b128 v[128:131], v20 offset:0
    ds_read_b128 v[132:135], v20 offset:256
    ds_read_b128 v[136:139], v20 offset:512
    ds_read_b128 v[140:143], v20 offset:768
    v_cvt_pk_bf16_f32 v3, v112, v113
    v_cvt_pk_bf16_f32 v4, v114, v115
    v_perm_b32 v32, v3, v3, v8
    v_perm_b32 v33, v3, v3, v10
    v_perm_b32 v34, v3, v3, v12
    v_perm_b32 v35, v3, v3, v14
    v_perm_b32 v36, v3, v3, v9
    v_perm_b32 v37, v3, v3, v11
    v_perm_b32 v38, v3, v3, v13
    v_perm_b32 v39, v3, v3, v15
    v_perm_b32 v40, v4, v4, v8
    v_perm_b32 v41, v4, v4, v10
    v_perm_b32 v42, v4, v4, v12
    v_perm_b32 v43, v4, v4, v14
    v_perm_b32 v44, v4, v4, v9
    v_perm_b32 v45, v4, v4, v11
    v_perm_b32 v46, v4, v4, v13
    v_perm_b32 v47, v4, v4, v15
    s_waitcnt lgkmcnt(3)
    v_mfma_f32_16x16x32_bf16 v[24:27], v[32:35], v[128:131], 0
    s_waitcnt lgkmcnt(2)
    v_mfma_f32_16x16x32_bf16 v[24:27], v[36:39], v[132:135], v[24:27]
    s_waitcnt lgkmcnt(1)
    v_mfma_f32_16x16x32_bf16 v[24:27], v[40:43], v[136:139], v[24:27]
    s_waitcnt lgkmcnt(0)
    v_mfma_f32_16x16x32_bf16 v[24:27], v[44:47], v[140:143], v[24:27]
    s_add_u32 s56, s55, 84
    s_cmp_ge_u32 s53, s56
    s_cbranch_scc1 SC_61
    s_branch SD_63
SP_62:
    s_sleep 1
SD_63:
    ds_read_b32 v2, v1 offset:0
    s_sub_u32 s34, s34, 1
    s_cbranch_scc1 L_end
    s_waitcnt lgkmcnt(0)
    v_readfirstlane_b32 s35, v2
    s_cmp_lt_u32 s35, s56
    s_cbranch_scc1 SP_62
    s_mov_b32 s53, s35
SC_61:
    ds_read_b128 v[128:131], v20 offset:16384
    ds_read_b128 v[132:135], v20 offset:16640
    ds_read_b128 v[136:139], v20 offset:16896
    ds_read_b128 v[140:143], v20 offset:17152
    v_cvt_pk_bf16_f32 v3, v116, v117
    v_cvt_pk_bf16_f32 v4, v118, v119
    v_perm_b32 v48, v3, v3, v8
    v_perm_b32 v49, v3, v3, v10
    v_perm_b32 v50, v3, v3, v12
    v_perm_b32 v51, v3, v3, v14
    v_perm_b32 v52, v3, v3, v9
    v_perm_b32 v53, v3, v3, v11
    v_perm_b32 v54, v3, v3, v13
    v_perm_b32 v55, v3, v3, v15
    v_perm_b32 v56, v4, v4, v8
    v_perm_b32 v57, v4, v4, v10
    v_perm_b32 v58, v4, v4, v12
    v_perm_b32 v59, v4, v4, v14
    v_perm_b32 v60, v4, v4, v9
    v_perm_b32 v61, v4, v4, v11
    v_perm_b32 v62, v4, v4, v13
    v_perm_b32 v63, v4, v4, v15
    s_waitcnt lgkmcnt(3)
    v_mfma_f32_16x16x32_bf16 v[24:27], v[48:51], v[128:131], v[24:27]
    s_waitcnt lgkmcnt(2)
    v_mfma_f32_16x16x32_bf16 v[24:27], v[52:55], v[132:135], v[24:27]
    s_waitcnt lgkmcnt(1)
    v_mfma_f32_16x16x32_bf16 v[24:27], v[56:59], v[136:139], v[24:27]
    s_waitcnt lgkmcnt(0)
    v_mfma_f32_16x16x32_bf16 v[24:27], v[60:63], v[140:143], v[24:27]
    s_add_u32 s56, s55, 100
    s_cmp_ge_u32 s53, s56
    s_cbranch_scc1 SC_64
    s_branch SD_66
SP_65:
    s_sleep 1
SD_66:
    ds_read_b32 v2, v1 offset:0
    s_sub_u32 s34, s34, 1
    s_cbranch_scc1 L_end
    s_waitcnt lgkmcnt(0)
    v_readfirstlane_b32 s35, v2
    s_cmp_lt_u32 s35, s56
    s_cbranch_scc1 SP_65
    s_mov_b32 s53, s35
SC_64:
    ds_read_b128 v[128:131], v20 offset:32768
    ds_read_b128 v[132:135], v20 offset:33024
    ds_read_b128 v[136:139], v20 offset:33280
    ds_read_b128 v[140:143], v20 offset:33536
    v_cvt_pk_bf16_f32 v3, v120, v121
    v_cvt_pk_bf16_f32 v4, v122, v123
    v_perm_b32 v64, v3, v3, v8
    v_perm_b32 v65, v3, v3, v10
    v_perm_b32 v66, v3, v3, v12
    v_perm_b32 v67, v3, v3, v14
    v_perm_b32 v68, v3, v3, v9
    v_perm_b32 v69, v3, v3, v11
    v_perm_b32 v70, v3, v3, v13
    v_perm_b32 v71, v3, v3, v15
    v_perm_b32 v72, v4, v4, v8
    v_perm_b32 v73, v4, v4, v10
    v_perm_b32 v74, v4, v4, v12
    v_perm_b32 v75, v4, v4, v14
    v_perm_b32 v76, v4, v4, v9
    v_perm_b32 v77, v4, v4, v11
    v_perm_b32 v78, v4, v4, v13
    v_perm_b32 v79, v4, v4, v15
    s_waitcnt lgkmcnt(3)
    v_mfma_f32_16x16x32_bf16 v[24:27], v[64:67], v[128:131], v[24:27]
    s_waitcnt lgkmcnt(2)
    v_mfma_f32_16x16x32_bf16 v[24:27], v[68:71], v[132:135], v[24:27]
    s_waitcnt lgkmcnt(1)
    v_mfma_f32_16x16x32_bf16 v[24:27], v[72:75], v[136:139], v[24:27]
    s_waitcnt lgkmcnt(0)
    v_mfma_f32_16x16x32_bf16 v[24:27], v[76:79], v[140:143], v[24:27]
    v_cvt_pk_bf16_f32 v3, v124, v125
    v_cvt_pk_bf16_f32 v4, v126, v127
    v_perm_b32 v80, v3, v3, v8
    v_perm_b32 v81, v3, v3, v10
    v_perm_b32 v82, v3, v3, v12
    v_perm_b32 v83, v3, v3, v14
    v_perm_b32 v84, v3, v3, v9
    v_perm_b32 v85, v3, v3, v11
    v_perm_b32 v86, v3, v3, v13
    v_perm_b32 v87, v3, v3, v15
    v_perm_b32 v88, v4, v4, v8
    v_perm_b32 v89, v4, v4, v10
    v_perm_b32 v90, v4, v4, v12
    v_perm_b32 v91, v4, v4, v14
    v_perm_b32 v92, v4, v4, v9
    v_perm_b32 v93, v4, v4, v11
    v_perm_b32 v94, v4, v4, v13
    v_perm_b32 v95, v4, v4, v15
    s_setprio 2
    s_cmp_eq_u32 s44, 3
    s_cbranch_scc1 L_Afin
    s_add_u32 s56, s55, 116
    s_cmp_ge_u32 s53, s56
    s_cbranch_scc1 SC_67
SP_68:
    ds_read_b32 v2, v1 offset:0
    s_sub_u32 s34, s34, 1
    s_cbranch_scc1 L_end
    s_waitcnt lgkmcnt(0)
    v_readfirstlane_b32 s35, v2
    s_cmp_lt_u32 s35, s56
    s_cbranch_scc1 SP_68
    s_mov_b32 s53, s35
SC_67:
    ds_read_b128 v[128:131], v20 offset:49152
    ds_read_b128 v[132:135], v20 offset:49408
    ds_read_b128 v[136:139], v20 offset:49664
    ds_read_b128 v[140:143], v20 offset:49920
    s_waitcnt lgkmcnt(3)
    v_mfma_f32_16x16x32_bf16 v[24:27], v[80:83], v[128:131], v[24:27]
    s_waitcnt lgkmcnt(2)
    v_mfma_f32_16x16x32_bf16 v[24:27], v[84:87], v[132:135], v[24:27]
    s_waitcnt lgkmcnt(1)
    v_mfma_f32_16x16x32_bf16 v[24:27], v[88:91], v[136:139], v[24:27]
    s_waitcnt lgkmcnt(0)
    v_mfma_f32_16x16x32_bf16 v[24:27], v[92:95], v[140:143], v[24:27]
    v_mov_b32 v4, 1
    s_nop 6
    ds_write_b128 v148, v[24:27]
    s_mov_b64 exec, 1
    ds_add_u32 v1, v4 offset:20
    s_mov_b64 exec, -1
    s_branch L_A2
L_Aslow:
SP_70:
    ds_read_b32 v2, v1 offset:20
    s_sub_u32 s34, s34, 1
    s_cbranch_scc1 L_end
    s_waitcnt lgkmcnt(0)
    v_readfirstlane_b32 s35, v2
    s_cmp_lt_u32 s35, 3
    s_cbranch_scc1 SP_70
    ds_read_b32 v4, v1 offset:20
    ds_read_b128 v[40:43], v147 offset:0
    ds_read_b128 v[44:47], v147 offset:1024
    ds_read_b128 v[48:51], v147 offset:2048
    s_branch L_Achk
L_Afin:
    s_add_u32 s56, s55, 116
    s_cmp_ge_u32 s53, s56
    s_cbranch_scc1 SC_72
SP_73:
    ds_read_b32 v2, v1 offset:0
    s_sub_u32 s34, s34, 1
    s_cbranch_scc1 L_end
    s_waitcnt lgkmcnt(0)
    v_readfirstlane_b32 s35, v2
    s_cmp_lt_u32 s35, s56
    s_cbranch_scc1 SP_73
    s_mov_b32 s53, s35
SC_72:
    ds_read_b128 v[128:131], v20 offset:49152
    ds_read_b128 v[132:135], v20 offset:49408
    ds_read_b128 v[136:139], v20 offset:49664
    ds_read_b128 v[140:143], v20 offset:49920
    ds_read_b32 v4, v1 offset:20
    ds_read_b128 v[40:43], v147 offset:0
    ds_read_b128 v[44:47], v147 offset:1024
    ds_read_b128 v[48:51], v147 offset:2048
    s_waitcnt lgkmcnt(7)
    v_mfma_f32_16x16x32_bf16 v[24:27], v[80:83], v[128:131], v[24:27]
    s_waitcnt lgkmcnt(6)
    v_mfma_f32_16x16x32_bf16 v[24:27], v[84:87], v[132:135], v[24:27]
    s_waitcnt lgkmcnt(5)
    v_mfma_f32_16x16x32_bf16 v[24:27], v[88:91], v[136:139], v[24:27]
    s_waitcnt lgkmcnt(4)
    v_mfma_f32_16x16x32_bf16 v[24:27], v[92:95], v[140:143], v[24:27]
L_Achk:
    s_waitcnt lgkmcnt(0)
    v_readfirstlane_b32 s35, v4
    s_cmp_lt_u32 s35, 3
    s_cbranch_scc1 L_Aslow
    v_add_f32 v40, v40, v44
    v_add_f32 v41, v41, v45
    v_add_f32 v42, v42, v46
    v_add_f32 v43, v43, v47
    v_add_f32 v40, v40, v48
    v_add_f32 v41, v41, v49
    v_add_f32 v42, v42, v50
    v_add_f32 v43, v43, v51
    v_add_f32 v40, v40, v24
    v_add_f32 v41, v41, v25
    v_add_f32 v42, v42, v26
    v_add_f32 v43, v43, v27
    v_mul_f32 v40, v40, v153
    v_mul_f32 v41, v41, v153
    v_mul_f32 v42, v42, v153
    v_mul_f32 v43, v43, v153
    v_cvt_pk_bf16_f32 v164, v40, v41
    v_cvt_pk_bf16_f32 v166, v42, v43
    s_cmp_eq_u32 s58, 1
    s_cbranch_scc1 SAFE_75
    buffer_store_dwordx4 v[164:167], v144, s[40:43], s48 offen
BACK_76:
    v_mov_b32 v2, 1
    ds_write_b32 v1, v2 offset:24
L_A2:
    s_cmp_ge_u32 s31, 9
    s_cbranch_scc1 AEND_77
    s_lshl_b32 s45, s44, 1
    s_nop 0
    v_mov_b32 v24, 0
    v_mov_b32 v25, 0
    v_mov_b32 v26, 0
    v_mov_b32 v27, 0
L_A3:
    s_lshl_b32 s52, s65, 14
    s_add_u32 s52, s52, s57
    s_add_u32 s52, s52, 65536
    s_lshl_b32 s54, s65, 9
    s_add_u32 s54, s54, s57
    s_add_u32 s54, s54, 20480
    v_lshlrev_b32 v16, 4, v0
    v_lshrrev_b32 v19, 2, v7
    s_lshl_b32 s48, s45, 11
    s_add_u32 s52, s52, s48
    s_lshr_b32 s48, s45, 2
    s_lshl_b32 s48, s48, 6
    s_add_u32 s48, s48, 162560
    v_add_u32 v19, s48, v19
    v_lshl_add_u32 v17, v6, 9, v7
    s_lshl_b32 s48, s45, 12
    s_add_u32 s48, s48, 36864
    s_cmp_eq_u32 s45, 7
    s_cselect_b32 s48, 131072, s48
    v_add_u32 v17, s48, v17
    v_mov_b32 v5, 162304
    ds_read_b32 v18, v5
    s_lshl_b32 s55, s45, 2
    s_add_u32 s55, s55, 268
    v_lshrrev_b32 v3, 4, v0
    v_lshl_add_u32 v148, v3, 11, v7
    v_and_b32 v4, 8, v0
    v_cmp_eq_u32 vcc, 0, v4
    v_mov_b32 v3, 1073741824
    s_nop 0
    v_cndmask_b32 v148, v3, v148, vcc
    v_mov_b32 v149, 1
    s_lshl_b32 s46, s31, 13
    s_lshl_b32 s35, s30, 7
    s_add_u32 s46, s46, s35
    s_add_u32 s46, s46, 524288
    s_branch SD_79
SP_78:
    s_sleep 1
SD_79:
    ds_read_b32 v2, v1 offset:0
    s_sub_u32 s34, s34, 1
    s_cbranch_scc1 L_end
    s_waitcnt lgkmcnt(0)
    v_readfirstlane_b32 s35, v2
    s_cmp_lt_u32 s35, 256
    s_cbranch_scc1 SP_78
    s_setprio 2
G0_80:
    s_waitcnt vmcnt(0)
    buffer_load_dwordx4 v[32:35], v16, s[40:43], s52 offen sc1
SP_84:
    ds_read_b32 v2, v1 offset:0
    s_sub_u32 s34, s34, 1
    s_cbranch_scc1 L_end
    s_waitcnt lgkmcnt(0)
    v_readfirstlane_b32 s35, v2
    s_cmp_lt_u32 s35, 272
    s_cbranch_scc1 SP_84
    buffer_load_dwordx4 v[48:51], v16, s[40:43], s52 offen offset:1024 sc1
WT_83:
    ds_read_b32 v2, v1 offset:52
    ds_read2_b32 v[36:37], v19 offset0:0 offset1:8
    s_sub_u32 s34, s34, 1
    s_cbranch_scc1 L_end
    s_waitcnt lgkmcnt(0)
    v_readfirstlane_b32 s35, v2
    s_cmp_lt_u32 s35, 1
    s_cbranch_scc1 WT_83
    s_sub_u32 s34, s34, 4
    s_cbranch_scc1 L_end
    s_waitcnt vmcnt(1)
    v_cmpx_eq_u32 vcc, s33, v33
    v_cmpx_eq_u32 vcc, s33, v35
    s_cmp_eq_u64 exec, -1
    s_mov_b64 exec, -1
    s_cbranch_scc0 G0_80
    v_and_b32 v117, 0xffff0000, v32
    v_lshlrev_b32 v116, 16, v32
    v_and_b32 v119, 0xffff0000, v34
    v_lshlrev_b32 v118, 16, v34
    v_mul_f32 v116, v36, v116
    v_mul_f32 v117, v36, v117
    v_mul_f32 v118, v36, v118
    v_mul_f32 v119, v36, v119
PL_81:
    s_waitcnt vmcnt(0)
    ds_read_b32 v3, v1 offset:0
    v_cmpx_eq_u32 vcc, s33, v49
    v_cmpx_eq_u32 vcc, s33, v51
    s_cmp_eq_u64 exec, -1
    s_mov_b64 exec, -1
    s_cbranch_scc1 PK_86
    buffer_load_dwordx4 v[48:51], v16, s[40:43], s52 offen offset:1024 sc1
    s_sub_u32 s34, s34, 4
    s_cbranch_scc0 PL_81
    s_branch L_end
PK_86:
    v_lshlrev_b32 v40, 16, v48
    v_and_b32 v41, 0xffff0000, v48
    v_lshlrev_b32 v42, 16, v50
    v_and_b32 v43, 0xffff0000, v50
PD_82:
    v_fmac_f32 v116, v37, v40
    v_fmac_f32 v117, v37, v41
    v_fmac_f32 v118, v37, v42
    v_fmac_f32 v119, v37, v43
    s_waitcnt lgkmcnt(0)
    v_readfirstlane_b32 s53, v3
    s_cmp_lt_u32 s53, s55
    s_cbranch_scc1 WO_87
    ds_read_b128 v[128:131], v17 offset:0
    ds_read_b128 v[132:135], v17 offset:128
    ds_read_b128 v[136:139], v17 offset:256
    ds_read_b128 v[140:143], v17 offset:384
WO_87:
    v_add_f32_dpp v116, v116, v116 quad_perm:[1,0,3,2] row_mask:0xf bank_mask:0xf
    v_add_f32_dpp v117, v117, v117 quad_perm:[1,0,3,2] row_mask:0xf bank_mask:0xf
    v_add_f32_dpp v118, v118, v118 quad_perm:[1,0,3,2] row_mask:0xf bank_mask:0xf
    v_add_f32_dpp v119, v119, v119 quad_perm:[1,0,3,2] row_mask:0xf bank_mask:0xf
    v_add_f32_dpp v116, v116, v116 quad_perm:[2,3,0,1] row_mask:0xf bank_mask:0xf
    v_add_f32_dpp v117, v117, v117 quad_perm:[2,3,0,1] row_mask:0xf bank_mask:0xf
    v_add_f32_dpp v118, v118, v118 quad_perm:[2,3,0,1] row_mask:0xf bank_mask:0xf
    v_add_f32_dpp v119, v119, v119 quad_perm:[2,3,0,1] row_mask:0xf bank_mask:0xf
    v_add_f32_dpp v116, v116, v116 row_half_mirror row_mask:0xf bank_mask:0xf
    v_add_f32_dpp v117, v117, v117 row_half_mirror row_mask:0xf bank_mask:0xf
    v_add_f32_dpp v118, v118, v118 row_half_mirror row_mask:0xf bank_mask:0xf
    v_add_f32_dpp v119, v119, v119 row_half_mirror row_mask:0xf bank_mask:0xf
    v_cvt_pk_bf16_f32 v124, v116, v117
    v_cvt_pk_bf16_f32 v125, v118, v119
    v_perm_b32 v96, v124, v124, v8
    v_perm_b32 v97, v124, v124, v10
    v_perm_b32 v98, v124, v124, v12
    v_perm_b32 v99, v124, v124, v14
    s_cmp_lt_u32 s53, s55
    s_cbranch_scc1 WO_88
    s_waitcnt lgkmcnt(0)
    v_mfma_f32_16x16x32_bf16 v[28:31], v[96:99], v[128:131], 0
    v_perm_b32 v100, v124, v124, v9
    v_perm_b32 v101, v124, v124, v11
    v_perm_b32 v102, v124, v124, v13
    v_perm_b32 v103, v124, v124, v15
    s_nop 1
    v_mfma_f32_16x16x32_bf16 v[28:31], v[100:103], v[132:135], v[28:31]
    v_perm_b32 v104, v125, v125, v8
    v_perm_b32 v105, v125, v125, v10
    v_perm_b32 v106, v125, v125, v12
    v_perm_b32 v107, v125, v125, v14
    s_nop 1
    v_mfma_f32_16x16x32_bf16 v[28:31], v[104:107], v[136:139], v[28:31]
    v_perm_b32 v108, v125, v125, v9
    v_perm_b32 v109, v125, v125, v11
    v_perm_b32 v110, v125, v125, v13
    v_perm_b32 v111, v125, v125, v15
    s_nop 1
    v_mfma_f32_16x16x32_bf16 v[28:31], v[108:111], v[140:143], v[28:31]
WO_89:
    ds_read_b32 v4, v1 offset:32
    ds_read_b64 v[152:153], v151 offset:0
    ds_read_b64 v[154:155], v151 offset:1024
    ds_read_b64 v[156:157], v151 offset:2048
    ds_read_b64 v[158:159], v151 offset:3072
    s_nop 2
    v_fmac_f32 v24, v18, v28
    v_fmac_f32 v25, v18, v29
    v_fmac_f32 v26, v18, v30
    v_fmac_f32 v27, v18, v31
    s_branch L_fin
WO_88:
    v_perm_b32 v100, v124, v124, v9
    v_perm_b32 v101, v124, v124, v11
    v_perm_b32 v102, v124, v124, v13
    v_perm_b32 v103, v124, v124, v15
    v_perm_b32 v104, v125, v125, v8
    v_perm_b32 v105, v125, v125, v10
    v_perm_b32 v106, v125, v125, v12
    v_perm_b32 v107, v125, v125, v14
    v_perm_b32 v108, v125, v125, v9
    v_perm_b32 v109, v125, v125, v11
    v_perm_b32 v110, v125, v125, v13
    v_perm_b32 v111, v125, v125, v15
SP_90:
    ds_read_b32 v2, v1 offset:0
    s_sub_u32 s34, s34, 1
    s_cbranch_scc1 L_end
    s_waitcnt lgkmcnt(0)
    v_readfirstlane_b32 s35, v2
    s_cmp_lt_u32 s35, s55
    s_cbranch_scc1 SP_90
    ds_read_b128 v[128:131], v17 offset:0
    ds_read_b128 v[132:135], v17 offset:128
    ds_read_b128 v[136:139], v17 offset:256
    ds_read_b128 v[140:143], v17 offset:384
    s_waitcnt lgkmcnt(3)
    v_mfma_f32_16x16x32_bf16 v[28:31], v[96:99], v[128:131], 0
    s_waitcnt lgkmcnt(2)
    v_mfma_f32_16x16x32_bf16 v[28:31], v[100:103], v[132:135], v[28:31]
    s_waitcnt lgkmcnt(1)
    v_mfma_f32_16x16x32_bf16 v[28:31], v[104:107], v[136:139], v[28:31]
    s_waitcnt lgkmcnt(0)
    v_mfma_f32_16x16x32_bf16 v[28:31], v[108:111], v[140:143], v[28:31]
    s_branch WO_89
AEND_77:
    s_endpgm
L_G:
    v_lshlrev_b32 v19, 4, v0
    s_mov_b32 m0, 147456
    s_waitcnt lgkmcnt(0)
    s_load_dword s33, s[28:29], 0
    s_mov_b32 s52, s4
    s_mov_b32 s53, s5
    s_mov_b32 s54, 1152
    s_mov_b32 s55, 0x20000
    s_mov_b32 s44, s22
    s_mov_b32 s45, s23
    s_mov_b32 s46, 1152
    s_mov_b32 s47, 0x20000
    buffer_load_dwordx4 v19, s[52:55], 0 offen lds
    buffer_load_dwordx4 v19, s[52:55], 0 offen offset:1024 lds
    s_mov_b32 m0, 149504
    s_nop 0
    buffer_load_dwordx4 v19, s[44:47], 0 offen lds
    buffer_load_dwordx4 v19, s[44:47], 0 offen offset:1024 lds
    s_mov_b32 s40, s28
    s_mov_b32 s41, s29
    s_mov_b32 s42, 3145728
    s_mov_b32 s43, 0x20000
    s_getreg_b32 s55, hwreg(HW_REG_XCC_ID, 0, 4)
    v_lshlrev_b32 v19, 4, v0
    v_and_b32 v18, 0x1f0, v19
    v_add_u32 v16, 147456, v19
    v_mov_b32 v20, 0
    s_lshr_b32 s44, s2, 3
    s_lshl_b32 s44, s44, 4
    s_add_u32 s44, s44, s32
    s_add_u32 s44, s44, 16384
    s_add_u32 s48, s44, 98304
    v_mov_b32 v3, 1
    s_barrier
    s_waitcnt vmcnt(0)
    ds_write_b32 v1, v3 offset:48
    s_waitcnt lgkmcnt(0)
    s_add_u32 s59, s33, 0x9E3779B0
    s_and_b32 s33, s59, 0xfffffff0
    s_or_b32 s54, s33, s55
    v_mov_b32 v2, s59
    v_mov_b32 v3, 1
    ds_write_b64 v1, v[2:3] offset:8
    v_mov_b32 v21, s54
    s_mov_b64 exec, 1
    buffer_store_dwordx2 v[20:21], v19, s[40:43], s44 offen
    s_mov_b64 exec, -1
    ds_read_b128 v[20:23], v16
    ds_read_b128 v[24:27], v16 offset:1024
    ds_read_b128 v[28:31], v16 offset:2048
    ds_read_b128 v[32:35], v16 offset:3072
    v_mov_b32 v40, 0
    s_waitcnt lgkmcnt(0)
    v_lshlrev_b32 v2, 16, v20
    v_and_b32 v3, 0xffff0000, v20
    v_lshlrev_b32 v4, 16, v28
    v_and_b32 v5, 0xffff0000, v28
    v_mul_f32 v2, v2, v4
    v_mul_f32 v3, v3, v5
    v_cvt_pk_bf16_f32 v2, v2, v3
    v_lshlrev_b32 v3, 16, v2
    v_and_b32 v2, 0xffff0000, v2
    v_add_f32 v40, v40, v3
    v_add_f32 v40, v40, v2
    v_lshlrev_b32 v2, 16, v21
    v_and_b32 v3, 0xffff0000, v21
    v_lshlrev_b32 v4, 16, v29
    v_and_b32 v5, 0xffff0000, v29
    v_mul_f32 v2, v2, v4
    v_mul_f32 v3, v3, v5
    v_cvt_pk_bf16_f32 v2, v2, v3
    v_lshlrev_b32 v3, 16, v2
    v_and_b32 v2, 0xffff0000, v2
    v_add_f32 v40, v40, v3
    v_add_f32 v40, v40, v2
    v_lshlrev_b32 v2, 16, v22
    v_and_b32 v3, 0xffff0000, v22
    v_lshlrev_b32 v4, 16, v30
    v_and_b32 v5, 0xffff0000, v30
    v_mul_f32 v2, v2, v4
    v_mul_f32 v3, v3, v5
    v_cvt_pk_bf16_f32 v2, v2, v3
    v_lshlrev_b32 v3, 16, v2
    v_and_b32 v2, 0xffff0000, v2
    v_add_f32 v40, v40, v3
    v_add_f32 v40, v40, v2
    v_lshlrev_b32 v2, 16, v23
    v_and_b32 v3, 0xffff0000, v23
    v_lshlrev_b32 v4, 16, v31
    v_and_b32 v5, 0xffff0000, v31
    v_mul_f32 v2, v2, v4
    v_mul_f32 v3, v3, v5
    v_cvt_pk_bf16_f32 v2, v2, v3
    v_lshlrev_b32 v3, 16, v2
    v_and_b32 v2, 0xffff0000, v2
    v_add_f32 v40, v40, v3
    v_add_f32 v40, v40, v2
    v_lshlrev_b32 v2, 16, v24
    v_and_b32 v3, 0xffff0000, v24
    v_lshlrev_b32 v4, 16, v32
    v_and_b32 v5, 0xffff0000, v32
    v_mul_f32 v2, v2, v4
    v_mul_f32 v3, v3, v5
    v_cvt_pk_bf16_f32 v2, v2, v3
    v_lshlrev_b32 v3, 16, v2
    v_and_b32 v2, 0xffff0000, v2
    v_add_f32 v40, v40, v3
    v_add_f32 v40, v40, v2
    v_lshlrev_b32 v2, 16, v25
    v_and_b32 v3, 0xffff0000, v25
    v_lshlrev_b32 v4, 16, v33
    v_and_b32 v5, 0xffff0000, v33
    v_mul_f32 v2, v2, v4
    v_mul_f32 v3, v3, v5
    v_cvt_pk_bf16_f32 v2, v2, v3
    v_lshlrev_b32 v3, 16, v2
    v_and_b32 v2, 0xffff0000, v2
    v_add_f32 v40, v40, v3
    v_add_f32 v40, v40, v2
    v_lshlrev_b32 v2, 16, v26
    v_and_b32 v3, 0xffff0000, v26
    v_lshlrev_b32 v4, 16, v34
    v_and_b32 v5, 0xffff0000, v34
    v_mul_f32 v2, v2, v4
    v_mul_f32 v3, v3, v5
    v_cvt_pk_bf16_f32 v2, v2, v3
    v_lshlrev_b32 v3, 16, v2
    v_and_b32 v2, 0xffff0000, v2
    v_add_f32 v40, v40, v3
    v_add_f32 v40, v40, v2
    v_lshlrev_b32 v2, 16, v27
    v_and_b32 v3, 0xffff0000, v27
    v_lshlrev_b32 v4, 16, v35
    v_and_b32 v5, 0xffff0000, v35
    v_mul_f32 v2, v2, v4
    v_mul_f32 v3, v3, v5
    v_cvt_pk_bf16_f32 v2, v2, v3
    v_lshlrev_b32 v3, 16, v2
    v_and_b32 v2, 0xffff0000, v2
    v_add_f32 v40, v40, v3
    v_add_f32 v40, v40, v2
    s_nop 1
    v_add_f32_dpp v40, v40, v40 quad_perm:[1,0,3,2] row_mask:0xf bank_mask:0xf
    s_nop 1
    v_add_f32_dpp v40, v40, v40 quad_perm:[2,3,0,1] row_mask:0xf bank_mask:0xf
    s_nop 1
    v_add_f32_dpp v40, v40, v40 row_half_mirror row_mask:0xf bank_mask:0xf
    s_nop 1
    v_add_f32_dpp v40, v40, v40 row_ror:8 row_mask:0xf bank_mask:0xf
    v_mov_b32 v2, v40
    s_nop 1
    v_permlane32_swap_b32 v2, v40
    s_nop 0
    v_add_f32 v40, v2, v40
    v_mov_b32 v2, v40
    s_nop 1
    v_permlane16_swap_b32 v2, v40
    s_nop 0
    v_add_f32 v40, v2, v40
    v_cvt_pk_bf16_f32 v40, v40, v40
    v_and_b32 v40, 0xffff0000, v40
    s_mov_b32 s47, 1069066811
    v_mul_f32 v40, s47, v40
    v_exp_f32 v40, -v40
    s_nop 0
    v_add_f32 v40, 1.0, v40
    v_rcp_f32 v40, v40
    s_nop 0
    v_cvt_pk_bf16_f32 v40, v40, v40
    v_and_b32 v40, 0xffff0000, v40
    v_sub_f32 v41, 1.0, v40
    v_cvt_pk_bf16_f32 v41, v41, v41
    v_and_b32 v41, 0xffff0000, v41
    v_mov_b32 v4, 162304
    ds_write_b64 v4, v[40:41]
    v_bfe_u32 v2, v0, 3, 1
    v_lshl_add_u32 v21, v2, 3, v7
    v_bfe_u32 v2, v0, 4, 1
    v_lshl_add_u32 v21, v2, 2, v21
    v_lshrrev_b32 v2, 5, v0
    v_lshl_add_u32 v21, v2, 7, v21
    v_add_u32 v21, 161024, v21
    s_lshl_b32 s57, s65, 13
    s_add_u32 s57, s57, s32
    s_branch SD_93
SP_92:
    s_sleep 2
SD_93:
    ds_read_b32 v2, v1 offset:0
    s_sub_u32 s34, s34, 1
    s_cbranch_scc1 L_end
    s_waitcnt lgkmcnt(0)
    v_readfirstlane_b32 s35, v2
    s_cmp_lt_u32 s35, 140
    s_cbranch_scc1 SP_92
    s_mov_b32 s56, 0
    s_mov_b32 s49, 0
L_qpoll:
    s_cmp_eq_u32 s56, 6
    s_cbranch_scc1 L_qsafe1
L_qback1:
    s_cmp_ge_u32 s56, 6
    s_cselect_b32 s35, s56, 1
    s_bitcmp0_b32 s35, 0
    s_cselect_b32 s35, 98304, 0
    s_add_u32 s44, s57, s35
    s_add_u32 s45, s32, s35
    s_add_u32 s45, s45, 16384
    s_add_u32 s46, s44, 4096
    s_add_u32 s56, s56, 1
    buffer_load_dwordx4 v[32:35], v19, s[40:43], s44 offen offset:0 sc1
    buffer_load_dwordx4 v[36:39], v19, s[40:43], s44 offen offset:1024 sc1
    buffer_load_dwordx4 v[40:43], v19, s[40:43], s44 offen offset:2048 sc1
    buffer_load_dwordx4 v[44:47], v19, s[40:43], s44 offen offset:3072 sc1
    buffer_load_dwordx4 v[48:51], v19, s[40:43], s46 offen offset:0 sc1
    buffer_load_dwordx4 v[52:55], v19, s[40:43], s46 offen offset:1024 sc1
    buffer_load_dwordx4 v[56:59], v19, s[40:43], s46 offen offset:2048 sc1
    buffer_load_dwordx4 v[60:63], v19, s[40:43], s46 offen offset:3072 sc1
    buffer_load_dwordx2 v[64:65], v18, s[40:43], s45 offen sc1
    s_sub_u32 s34, s34, 4
    s_cbranch_scc1 L_end
    s_waitcnt vmcnt(0)
    v_and_b32 v64, 0xfffffff0, v65
    v_cmpx_eq_u32 vcc, s33, v33
    v_cmpx_eq_u32 vcc, s33, v35
    v_cmpx_eq_u32 vcc, s33, v37
    v_cmpx_eq_u32 vcc, s33, v39
    v_cmpx_eq_u32 vcc, s33, v41
    v_cmpx_eq_u32 vcc, s33, v43
    v_cmpx_eq_u32 vcc, s33, v45
    v_cmpx_eq_u32 vcc, s33, v47
    v_cmpx_eq_u32 vcc, s33, v49
    v_cmpx_eq_u32 vcc, s33, v51
    v_cmpx_eq_u32 vcc, s33, v53
    v_cmpx_eq_u32 vcc, s33, v55
    v_cmpx_eq_u32 vcc, s33, v57
    v_cmpx_eq_u32 vcc, s33, v59
    v_cmpx_eq_u32 vcc, s33, v61
    v_cmpx_eq_u32 vcc, s33, v63
    v_cmpx_eq_u32 vcc, s33, v64
    s_cmp_eq_u64 exec, -1
    s_mov_b64 exec, -1
    s_cbranch_scc0 L_qpoll
    v_cmp_ne_u32 vcc, s54, v65
    s_cmp_eq_u64 vcc, 0
    s_cselect_b32 s50, 2, 1
    s_add_u32 s35, s50, s49
    s_cmp_eq_u32 s35, 1
    s_cbranch_scc1 L_qsafe2
L_qback2:
    v_add_f32 v32, v32, v40
    v_add_f32 v48, v48, v56
    v_add_f32 v32, v32, v48
    v_add_f32 v34, v34, v42
    v_add_f32 v50, v50, v58
    v_add_f32 v34, v34, v50
    v_add_f32 v36, v36, v44
    v_add_f32 v52, v52, v60
    v_add_f32 v36, v36, v52
    v_add_f32 v38, v38, v46
    v_add_f32 v54, v54, v62
    v_add_f32 v38, v38, v54
    v_cvt_pk_bf16_f32 v2, v32, v34
    v_cvt_pk_bf16_f32 v3, v36, v38
    ds_write_b32 v21, v2
    ds_write_b32 v21, v3 offset:256
    v_mov_b32 v4, s50
    ds_write_b32 v1, v4 offset:4
    s_cmp_ge_u32 s31, 9
    s_cbranch_scc1 L_95
    s_mov_b32 s35, s50
    s_mov_b32 s58, s35
    s_cmp_eq_u32 s35, 1
    s_cselect_b32 s57, 1048576, 0
    s_add_u32 s57, s57, s32
    s_lshl_b32 s52, s65, 9
    s_add_u32 s52, s52, s57
    s_add_u32 s52, s52, 20480
    v_lshrrev_b32 v17, 2, v18
    v_add_u32 v17, 162560, v17
    s_branch SD_97
SP_96:
    s_sleep 2
SD_97:
    ds_read_b32 v2, v1 offset:0
    s_sub_u32 s34, s34, 1
    s_cbranch_scc1 L_end
    s_waitcnt lgkmcnt(0)
    v_readfirstlane_b32 s35, v2
    s_cmp_lt_u32 s35, 244
    s_cbranch_scc1 SP_96
    buffer_load_dwordx4 v[32:35], v18, s[40:43], s52 offen sc1
    s_sleep 8
    buffer_load_dwordx4 v[36:39], v18, s[40:43], s52 offen sc1
PL_98:
    s_waitcnt vmcnt(1)
    v_cmpx_eq_u32 vcc, s33, v33
    v_cmpx_eq_u32 vcc, s33, v35
    s_cmp_eq_u64 exec, -1
    s_mov_b64 exec, -1
    s_cbranch_scc1 PK_100
    buffer_load_dwordx4 v[32:35], v18, s[40:43], s52 offen sc1
    s_waitcnt vmcnt(1)
    v_cmpx_eq_u32 vcc, s33, v37
    v_cmpx_eq_u32 vcc, s33, v39
    s_cmp_eq_u64 exec, -1
    s_mov_b64 exec, -1
    s_cbranch_scc1 PK_101
    buffer_load_dwordx4 v[36:39], v18, s[40:43], s52 offen sc1
    s_sub_u32 s34, s34, 4
    s_cbranch_scc0 PL_98
    s_branch L_end
PK_100:
    v_mov_b32 v24, v32
    v_mov_b32 v25, v32
    v_mov_b32 v26, v34
    s_branch PD_99
PK_101:
    v_mov_b32 v24, v36
    v_mov_b32 v25, v36
    v_mov_b32 v26, v38
PD_99:
    s_nop 1
    v_max_f32_dpp v25, v25, v25 quad_perm:[1,0,3,2] row_mask:0xf bank_mask:0xf
    s_nop 1
    v_max_f32_dpp v25, v25, v25 quad_perm:[2,3,0,1] row_mask:0xf bank_mask:0xf
    s_nop 1
    v_max_f32_dpp v25, v25, v25 row_half_mirror row_mask:0xf bank_mask:0xf
    s_nop 1
    v_max_f32_dpp v25, v25, v25 row_mirror row_mask:0xf bank_mask:0xf
    v_sub_f32 v24, v24, v25
    v_mul_f32 v24, s47, v24
    v_exp_f32 v24, v24
    s_nop 0
    v_mul_f32 v24, v24, v26
    v_mov_b32 v25, v24
    s_nop 1
    v_add_f32_dpp v25, v25, v25 quad_perm:[1,0,3,2] row_mask:0xf bank_mask:0xf
    s_nop 1
    v_add_f32_dpp v25, v25, v25 quad_perm:[2,3,0,1] row_mask:0xf bank_mask:0xf
    s_nop 1
    v_add_f32_dpp v25, v25, v25 row_half_mirror row_mask:0xf bank_mask:0xf
    s_nop 1
    v_add_f32_dpp v25, v25, v25 row_mirror row_mask:0xf bank_mask:0xf
    v_rcp_f32 v25, v25
    v_mov_b32 v3, 1
    v_mul_f32 v24, v24, v25
    ds_write_b32 v17, v24
    ds_write_b32 v1, v3 offset:52
    s_branch L_94
L_95:
    s_mov_b32 s44, s24
    s_mov_b32 s45, s25
    s_mov_b32 s46, 1152
    s_mov_b32 s47, 0x20000
    s_cmp_lt_u32 s31, 12
    s_cbranch_scc1 L_94
    s_cmp_ge_u32 s30, 9
    s_cbranch_scc1 L_94
    s_sub_u32 s35, s31, 12
    s_lshl_b32 s52, s30, 2
    s_add_u32 s52, s52, s35
    s_lshl_b32 s52, s52, 11
    s_add_u32 s52, s52, 524288
    s_lshl_b32 s53, s30, 7
    s_and_b32 s56, s35, 1
    s_lshl_b32 s56, s56, 3
    s_add_u32 s53, s53, s56
    s_lshr_b32 s56, s35, 1
    s_lshl_b32 s56, s56, 2
    s_add_u32 s53, s53, s56
    v_cmp_gt_u32 vcc, 8, v0
    v_mov_b32 v3, 1073741824
    buffer_load_dwordx4 v[32:35], v19, s[40:43], s52 offen sc1
    v_cndmask_b32 v16, v3, v7, vcc
    buffer_load_dwordx4 v[36:39], v19, s[40:43], s52 offen offset:1024 sc1
    buffer_load_dword v40, v16, s[44:47], s53 offen
    s_waitcnt vmcnt(0)
    s_branch SD_103
SP_102:
    s_sleep 2
SD_103:
    ds_read_b32 v2, v1 offset:24
    s_sub_u32 s34, s34, 1
    s_cbranch_scc1 L_end
    s_waitcnt lgkmcnt(0)
    v_readfirstlane_b32 s35, v2
    s_cmp_lt_u32 s35, 1
    s_cbranch_scc1 SP_102
    buffer_load_dwordx4 v[32:35], v19, s[40:43], s52 offen sc1
    buffer_load_dwordx4 v[36:39], v19, s[40:43], s52 offen offset:1024 sc1
    s_sleep 1
    buffer_load_dwordx4 v[40:43], v19, s[40:43], s52 offen sc1
    buffer_load_dwordx4 v[44:47], v19, s[40:43], s52 offen offset:1024 sc1
    s_sleep 1
    buffer_load_dwordx4 v[48:51], v19, s[40:43], s52 offen sc1
    buffer_load_dwordx4 v[52:55], v19, s[40:43], s52 offen offset:1024 sc1
    s_sleep 1
    buffer_load_dwordx4 v[56:59], v19, s[40:43], s52 offen sc1
    buffer_load_dwordx4 v[60:63], v19, s[40:43], s52 offen offset:1024 sc1
PL_104:
    s_waitcnt vmcnt(6)
    v_cmpx_eq_u32 vcc, s33, v33
    v_cmpx_eq_u32 vcc, s33, v35
    v_cmpx_eq_u32 vcc, s33, v37
    v_cmpx_eq_u32 vcc, s33, v39
    s_cmp_eq_u64 exec, -1
    s_mov_b64 exec, -1
    s_cbranch_scc1 PK_106
    buffer_load_dwordx4 v[32:35], v19, s[40:43], s52 offen sc1
    buffer_load_dwordx4 v[36:39], v19, s[40:43], s52 offen offset:1024 sc1
    s_waitcnt vmcnt(6)
    v_cmpx_eq_u32 vcc, s33, v41
    v_cmpx_eq_u32 vcc, s33, v43
    v_cmpx_eq_u32 vcc, s33, v45
    v_cmpx_eq_u32 vcc, s33, v47
    s_cmp_eq_u64 exec, -1
    s_mov_b64 exec, -1
    s_cbranch_scc1 PK_107
    buffer_load_dwordx4 v[40:43], v19, s[40:43], s52 offen sc1
    buffer_load_dwordx4 v[44:47], v19, s[40:43], s52 offen offset:1024 sc1
    s_waitcnt vmcnt(6)
    v_cmpx_eq_u32 vcc, s33, v49
    v_cmpx_eq_u32 vcc, s33, v51
    v_cmpx_eq_u32 vcc, s33, v53
    v_cmpx_eq_u32 vcc, s33, v55
    s_cmp_eq_u64 exec, -1
    s_mov_b64 exec, -1
    s_cbranch_scc1 PK_108
    buffer_load_dwordx4 v[48:51], v19, s[40:43], s52 offen sc1
    buffer_load_dwordx4 v[52:55], v19, s[40:43], s52 offen offset:1024 sc1
    s_waitcnt vmcnt(6)
    v_cmpx_eq_u32 vcc, s33, v57
    v_cmpx_eq_u32 vcc, s33, v59
    v_cmpx_eq_u32 vcc, s33, v61
    v_cmpx_eq_u32 vcc, s33, v63
    s_cmp_eq_u64 exec, -1
    s_mov_b64 exec, -1
    s_cbranch_scc1 PK_109
    buffer_load_dwordx4 v[56:59], v19, s[40:43], s52 offen sc1
    buffer_load_dwordx4 v[60:63], v19, s[40:43], s52 offen offset:1024 sc1
    s_sub_u32 s34, s34, 4
    s_cbranch_scc0 PL_104
    s_branch L_end
PK_106:
    v_add_f32 v24, v32, v36
    v_add_f32 v26, v34, v38
    s_branch PD_105
PK_107:
    v_add_f32 v24, v40, v44
    v_add_f32 v26, v42, v46
    s_branch PD_105
PK_108:
    v_add_f32 v24, v48, v52
    v_add_f32 v26, v50, v54
    s_branch PD_105
PK_109:
    v_add_f32 v24, v56, v60
    v_add_f32 v26, v58, v62
PD_105:
    s_nop 1
    v_add_f32_dpp v24, v24, v24 row_ror:8 row_mask:0xf bank_mask:0xf
    v_add_f32_dpp v26, v26, v26 row_ror:8 row_mask:0xf bank_mask:0xf
    s_nop 1
    v_permlane32_swap_b32 v24, v26
    s_nop 0
    v_add_f32 v24, v24, v26
    v_mov_b32 v25, v24
    s_nop 1
    v_permlane16_swap_b32 v25, v24
    s_nop 0
    v_add_f32 v24, v24, v25
    v_mov_b32 v25, v24
    s_nop 1
    v_permlane32_swap_b32 v24, v25
    s_nop 0
    v_cvt_pk_bf16_f32 v2, v24, v25
    buffer_store_dword v2, v16, s[44:47], s53 offen
    s_cmp_lg_u32 s2, 192
    s_cbranch_scc1 L_94
    v_mov_b32 v3, s59
    s_mov_b64 exec, 1
    buffer_store_dword v3, v7, s[40:43], 0 offen sc1
    s_mov_b64 exec, -1
L_94:
    s_endpgm
L_qsafe1:
    s_mov_b32 s49, 1
    v_mov_b32 v66, 0
    v_mov_b32 v67, s54
    s_mov_b64 exec, 1
    buffer_store_dwordx2 v[66:67], v19, s[40:43], s48 offen sc1
    s_mov_b64 exec, -1
    s_cmp_ge_u32 s31, 8
    s_cbranch_scc1 L_qback1
    v_lshrrev_b32 v3, 4, v0
    v_lshl_add_u32 v76, v3, 7, v7
    v_and_b32 v4, 8, v0
    v_cmp_eq_u32 vcc, 0, v4
    v_mov_b32 v3, 1073741824
    s_nop 0
    v_cndmask_b32 v76, v3, v76, vcc
    s_branch SD_112
SP_111:
    s_sleep 1
SD_112:
    ds_read_b32 v2, v1 offset:44
    s_sub_u32 s34, s34, 1
    s_cbranch_scc1 L_end
    s_waitcnt lgkmcnt(0)
    v_readfirstlane_b32 s35, v2
    s_cmp_lt_u32 s35, 1
    s_cbranch_scc1 SP_111
    v_add_u32 v66, 151552, v19
    ds_read_b128 v[68:71], v66
    ds_read_b128 v[72:75], v66 offset:1024
    s_lshl_b32 s35, s31, 10
    s_add_u32 s35, s35, s57
    s_add_u32 s35, s35, 98304
    s_waitcnt lgkmcnt(0)
    buffer_store_dwordx4 v[68:71], v76, s[40:43], s35 offen sc1
    buffer_store_dwordx4 v[72:75], v76, s[40:43], s35 offen offset:512 sc1
    s_branch L_qback1
L_qsafe2:
    s_mov_b32 s49, 1
    v_mov_b32 v66, 0
    v_mov_b32 v67, s54
    s_mov_b64 exec, 1
    buffer_store_dwordx2 v[66:67], v19, s[40:43], s48 offen sc1
    s_mov_b64 exec, -1
    s_cmp_ge_u32 s31, 8
    s_cbranch_scc1 L_qback2
    v_lshrrev_b32 v3, 4, v0
    v_lshl_add_u32 v76, v3, 7, v7
    v_and_b32 v4, 8, v0
    v_cmp_eq_u32 vcc, 0, v4
    v_mov_b32 v3, 1073741824
    s_nop 0
    v_cndmask_b32 v76, v3, v76, vcc
    s_branch SD_115
SP_114:
    s_sleep 1
SD_115:
    ds_read_b32 v2, v1 offset:44
    s_sub_u32 s34, s34, 1
    s_cbranch_scc1 L_end
    s_waitcnt lgkmcnt(0)
    v_readfirstlane_b32 s35, v2
    s_cmp_lt_u32 s35, 1
    s_cbranch_scc1 SP_114
    v_add_u32 v66, 151552, v19
    ds_read_b128 v[68:71], v66
    ds_read_b128 v[72:75], v66 offset:1024
    s_lshl_b32 s35, s31, 10
    s_add_u32 s35, s35, s57
    s_add_u32 s35, s35, 98304
    s_waitcnt lgkmcnt(0)
    buffer_store_dwordx4 v[68:71], v76, s[40:43], s35 offen sc1
    buffer_store_dwordx4 v[72:75], v76, s[40:43], s35 offen offset:512 sc1
    s_branch L_qback2
SAFE_28:
    buffer_store_dwordx4 v[24:27], v18, s[40:43], s46 offen sc1
    buffer_store_dwordx4 v[28:31], v18, s[40:43], s45 offen sc1
    s_branch BACK_29
SAFE_56:
    buffer_store_dwordx4 v[160:163], v145, s[40:43], s49 offen sc1
    s_branch BACK_57
SAFE_75:
    buffer_store_dwordx4 v[164:167], v144, s[40:43], s48 offen sc1
    s_branch BACK_76
L_codeend:
    s_endpgm
.section .rodata,"a"
.p2align 6
.amdhsa_kernel gated_mix__sliding_block_cached__swiglu_ffn__decode_kernel
  .amdhsa_next_free_vgpr 168
  .amdhsa_next_free_sgpr 102
  .amdhsa_accum_offset 168
  .amdhsa_group_segment_fixed_size 0
  .amdhsa_kernarg_size 104
  .amdhsa_user_sgpr_count 2
  .amdhsa_user_sgpr_kernarg_segment_ptr 1
  .amdhsa_system_sgpr_workgroup_id_x 1
.end_amdhsa_kernel
```
